```python
import torch

def _softmax(x, axis=-1):
    return torch.softmax(x, dim=axis)
def _gelu(x):
    return torch.nn.functional.gelu(x, approximate="tanh")
def _silu(x):
    return torch.nn.functional.silu(x)
def _sigmoid(x):
    return torch.sigmoid(x)
def _layernorm(x, axis=-1, eps=1e-5):
    m = x.mean(dim=axis, keepdim=True)
    v = x.var(dim=axis, keepdim=True, unbiased=False)
    return (x - m) / torch.sqrt(v + eps)
def _scatter_add(tgt, idx, src, axis=0):
    return tgt.clone().index_add_(axis, idx, src)
def _segment_sum(src, seg, n):
    out = torch.zeros((n,) + src.shape[1:], dtype=src.dtype)
    return out.index_add_(0, seg, src)
def _pad(x, pw):
    flat = tuple(v for pair in reversed(pw) for v in pair)
    return torch.nn.functional.pad(x, flat)

kernel_name = 'parallel_sum__ssm_conv_s4__dense_activation_gelu__prompt'

def setup_inputs():

    _w = (lambda a: (lambda t: t.to(torch.bfloat16) if t.is_floating_point() else t)(torch.as_tensor(a)))
    def _A_setup():
        B, L, D, N = 1, 2048, 512, 128
        A_re = -(lambda _x: torch.exp(torch.as_tensor(_x)))((lambda *s: torch.randn(*s, dtype=torch.bfloat16) * 12.8)(D, N))
        A_im = torch.pi * (lambda *s: torch.randn(*s, dtype=torch.bfloat16) * 0.05)(D, N)
        B_re = (lambda *s: torch.randn(*s, dtype=torch.bfloat16) * 0.1)(D, N)
        B_im = (lambda *s: torch.randn(*s, dtype=torch.bfloat16) * 0.1)(D, N)
        C_re = (lambda *s: torch.randn(*s, dtype=torch.bfloat16) * 0.2)(D, N)
        C_im = (lambda *s: torch.randn(*s, dtype=torch.bfloat16) * 0.2)(D, N)
        log_dt = (lambda *s: torch.randn(*s, dtype=torch.bfloat16) * 0.05)(D) * 0.5 - 4.0
        Dskip = (lambda *s: torch.randn(*s, dtype=torch.bfloat16) * 0.05)(D)
        return {
            "u": _w((lambda *s: torch.randn(*s, dtype=torch.bfloat16) * 0.05)(B, L, D)),
            "A_re": _w(A_re),
            "A_im": _w(A_im),
            "B_re": _w(B_re),
            "B_im": _w(B_im),
            "C_re": _w(C_re),
            "C_im": _w(C_im),
            "log_dt": _w(log_dt),
            "Dskip": _w(Dskip),
        }
    _A_in = _A_setup()

    def _B_setup():
        B, S, D, F = 1, 2048, 512, 1792
        return {
            "x": _w((lambda *s: torch.randn(*s, dtype=torch.bfloat16) * 0.05)(B, S, D)),
            "w1": _w((lambda *s: torch.randn(*s, dtype=torch.bfloat16) * 0.8)(D, F) * (D ** -0.5)),
            "b1": _w((lambda *s: torch.randn(*s, dtype=torch.bfloat16) * 12.8)(F) * 0.01),
            "w2": _w((lambda *s: torch.randn(*s, dtype=torch.bfloat16) * 0.8)(F, D) * (F ** -0.5)),
            "b2": _w((lambda *s: torch.randn(*s, dtype=torch.bfloat16) * 12.8)(D) * 0.01),
        }
    _B_in = _B_setup()

    return {
        "A_u": _A_in["u"],
        "A_A_re": _A_in["A_re"],
        "A_A_im": _A_in["A_im"],
        "A_B_re": _A_in["B_re"],
        "A_B_im": _A_in["B_im"],
        "A_C_re": _A_in["C_re"],
        "A_C_im": _A_in["C_im"],
        "A_log_dt": _A_in["log_dt"],
        "A_Dskip": _A_in["Dskip"],
        "B_x": _B_in["x"],
        "B_w1": _B_in["w1"],
        "B_b1": _B_in["b1"],
        "B_w2": _B_in["w2"],
        "B_b2": _B_in["b2"],
    }

def reference(A_u, A_A_re, A_A_im, A_B_re, A_B_im, A_C_re, A_C_im, A_log_dt, A_Dskip, B_x, B_w1, B_b1, B_w2, B_b2):
    def _A_ref(u, A_re, A_im, B_re, B_im, C_re, C_im, log_dt, Dskip):
        Bsz, L, D = u.shape
        dt = torch.exp(log_dt)[:, None]
        A = A_re + 1j * A_im
        Bc = B_re + 1j * B_im
        Cc = C_re + 1j * C_im
        logdA = dt * A
        dB = dt * Bc
        l = (lambda x, dt: x.to(dt))(torch.arange(L), A_re.dtype)
        P = torch.exp(logdA[:, :, None] * l[None, None, :])
        K = torch.einsum("dn,dnl,dn->dl", Cc, P, dB).real
        L2 = 2 * L
        Kp = _pad(K, ((0, 0), (0, L)))
        up = (lambda x, *d: x.permute(*d))(u, 0, 2, 1)
        up = _pad(up, ((0, 0), (0, 0), (0, L)))
        Kf = (lambda x, axes=(-2,-1): torch.fft.rfft2(x.float(), dim=axes))(Kp[:, None, :], axes=(-2, -1))
        Uf = (lambda x, axes=(-2,-1): torch.fft.rfft2(x.float(), dim=axes))(up[:, :, None, :], axes=(-2, -1))
        Yf = Uf * Kf[None, :, :, :]
        y = (lambda x, s, axes=(-2,-1): torch.fft.irfft2(x, s=s, dim=axes).to(torch.bfloat16))(Yf, (1, L2), axes=(-2, -1))[:, :, 0, :L]
        y = (lambda x, *d: x.permute(*d))(y, 0, 2, 1) + u * Dskip[None, None, :]
        return y

    def _B_ref(x, w1, b1, w2, b2):
        h = torch.einsum("bsd,df->bsf", x, w1) + b1
        h = _gelu(h)
        return torch.einsum("bsf,fd->bsd", h, w2) + b2

    x = A_u
    xn = _layernorm(x, axis=-1)
    return x + _A_ref(xn, A_A_re, A_A_im, A_B_re, A_B_im, A_C_re, A_C_im, A_log_dt, A_Dskip) + _B_ref(xn, B_w1, B_b1, B_w2, B_b2)
```

```asm
; @launch grid=(256,1,1) block=(512,1,1) lds=163840
.amdgcn_target "amdgcn-amd-amdhsa--gfx950"
.text
.globl parallel_sum__ssm_conv_s4__dense_activation_gelu__prompt_kernel
.p2align 8
.type parallel_sum__ssm_conv_s4__dense_activation_gelu__prompt_kernel,@function
parallel_sum__ssm_conv_s4__dense_activation_gelu__prompt_kernel:
    s_cmp_ge_u32 s2, 256
    s_cbranch_scc1 L_exit
    s_add_u32 s2, s2, 224
    s_and_b32 s2, s2, 255
    s_load_dwordx2 s[40:41], s[0:1], 0
    s_load_dwordx8 s[44:51], s[0:1], 80
    s_load_dwordx4 s[52:55], s[0:1], 112
    s_load_dwordx2 s[42:43], s[0:1], 128
    v_lshrrev_b32 v1, 6, v0
    v_and_b32 v0, 63, v0
    s_and_b32 s23, s2, 7
    s_lshr_b32 s24, s2, 3
    v_readfirstlane_b32 s20, v1
    s_and_b32 s25, s24, 3
    s_lshr_b32 s77, s24, 2
    s_and_b32 s79, s77, 3
    s_cmp_eq_u32 s79, 3
    s_cselect_b32 s79, 4, 0
    s_xor_b32 s79, s79, s77
    s_lshl_b32 s78, s23, 2
    s_add_u32 s78, s78, s25
    s_mul_i32 s74, s23, 3584
    s_and_b32 s74, s74, 0xfffffc00
    s_cmp_eq_u32 s77, 7
    s_cselect_b32 s75, 7168, 0
    s_mul_i32 s75, s25, s75
    s_add_u32 s74, s74, s75
    s_sub_u32 s75, s74, 28672
    s_min_u32 s74, s74, s75
    s_and_b32 s39, s20, 3
    s_cmp_eq_u32 s77, 7
    s_cbranch_scc1 L_ln
    s_lshr_b32 s21, s23, 1
    s_lshl_b32 s21, s21, 2
    s_add_u32 s21, s21, s25
    s_and_b32 s22, s23, 1
    s_mul_i32 s22, s22, 7
    s_add_u32 s22, s22, s77
    s_load_dwordx8 s[56:63], s[0:1], 8
    s_load_dwordx8 s[64:71], s[0:1], 40
    s_cmp_lt_u32 s20, 4
    s_cbranch_scc1 L_g1_C
    s_lshr_b32 s28, s39, 1
    s_lshl_b32 s30, s2, 1
    s_add_u32 s30, s30, s28
    v_lshlrev_b32 v28, 1, v0
    v_mov_b32 v29, 0
    s_lshl_b32 s29, s30, 8
    s_and_b32 s28, s20, 1
    s_lshl_b32 s28, s28, 7
    s_add_u32 s29, s29, s28
    s_lshl_b32 s30, s30, 1
    s_mov_b32 s18, 1024
    s_mov_b32 s19, 0x00020000
    v_mov_b32 v244, 0
    v_mov_b32 v245, 0
    v_mov_b32 v246, 0
    v_mov_b32 v247, 0
    v_mov_b32 v248, 0
    v_mov_b32 v249, 0
    v_mov_b32 v250, 0
    v_mov_b32 v251, 0
    s_waitcnt lgkmcnt(0)
    s_mov_b32 s16, s68
    s_mov_b32 s17, s69
    buffer_load_short_d16_hi v250, v29, s[16:19], s30 offen
    s_mov_b32 s16, s70
    s_mov_b32 s17, s71
    buffer_load_short_d16_hi v251, v29, s[16:19], s30 offen
    s_mov_b32 s18, 131072
    s_mov_b32 s16, s56
    s_mov_b32 s17, s57
    buffer_load_short_d16_hi v244, v28, s[16:19], s29 offen
    s_mov_b32 s16, s58
    s_mov_b32 s17, s59
    buffer_load_short_d16_hi v245, v28, s[16:19], s29 offen
    s_mov_b32 s16, s60
    s_mov_b32 s17, s61
    buffer_load_short_d16_hi v246, v28, s[16:19], s29 offen
    s_mov_b32 s16, s62
    s_mov_b32 s17, s63
    buffer_load_short_d16_hi v247, v28, s[16:19], s29 offen
    s_mov_b32 s16, s64
    s_mov_b32 s17, s65
    buffer_load_short_d16_hi v248, v28, s[16:19], s29 offen
    s_mov_b32 s16, s66
    s_mov_b32 s17, s67
    buffer_load_short_d16_hi v249, v28, s[16:19], s29 offen
    s_getpc_b64 s[28:29]
L_pc0:
    s_sub_u32 s28, s28, L_pc0-parallel_sum__ssm_conv_s4__dense_activation_gelu__prompt_kernel
    s_subb_u32 s29, s29, 0
    s_lshl_b32 s30, s24, 2
    s_add_u32 s30, s30, s39
    s_mul_i32 s30, s30, 384
    v_lshl_add_u32 v30, v0, 7, s30
    v_min_u32 v30, L_exit-parallel_sum__ssm_conv_s4__dense_activation_gelu__prompt_kernel, v30
    s_mov_b64 exec, 7
    global_load_dword v252, v30, s[28:29]
    s_mov_b64 exec, -1
    s_branch L_g1_H
L_g1_C:
    s_nop 0
    v_lshrrev_b32 v28, 3, v0
    v_and_b32 v29, 7, v0
    v_lshrrev_b32 v30, 4, v0
    v_xor_b32 v31, v30, v29
    v_lshlrev_b32 v1, 10, v28
    v_lshl_add_u32 v1, v31, 4, v1
    v_xor_b32 v3, 64, v1
    v_add_u32 v3, 8192, v3
    v_and_b32 v31, 15, v0
    v_lshlrev_b32 v28, 2, v30
    v_xor_b32 v31, v31, v28
    v_mul_u32_u24 v2, 3584, v30
    v_lshl_add_u32 v2, v31, 4, v2
    s_lshl_b32 s25, s21, 17
    s_lshl_b32 s28, s39, 15
    s_add_u32 s25, s25, s28
    s_mul_i32 s26, s39, 57344
    s_lshl_b32 s28, s22, 8
    s_add_u32 s26, s26, s28
    s_lshl_b32 s27, s39, 12
    s_and_b32 s34, s20, 1
    s_lshr_b32 s35, s20, 1
    s_waitcnt lgkmcnt(0)
    s_add_u32 s42, s42, 0
    s_addc_u32 s43, s43, 0
    s_load_dword s76, s[42:43], 49152
    s_mov_b32 s4, s40
    s_mov_b32 s5, s41
    s_mov_b32 s6, 2097152
    s_mov_b32 s7, 0x00020000
    s_mov_b32 s8, s44
    s_mov_b32 s9, s45
    s_mov_b32 s10, 1835008
    s_mov_b32 s11, 0x00020000
    s_mov_b32 s12, s42
    s_mov_b32 s13, s43
    s_mov_b32 s14, 14680064
    s_mov_b32 s15, 0x00020000
    s_add_u32 m0, s27, 0
    s_add_u32 s31, s25, 0
    buffer_load_dwordx4 v1, s[4:7], s31 offen lds
    s_add_u32 m0, s27, 16384
    s_add_u32 s37, s26, 0
    buffer_load_dwordx4 v2, s[8:11], s37 offen lds
    s_add_u32 m0, s27, 1024
    s_add_u32 s31, s25, 0
    buffer_load_dwordx4 v3, s[4:7], s31 offen lds
    s_add_u32 m0, s27, 17408
    s_add_u32 s37, s26, 14336
    buffer_load_dwordx4 v2, s[8:11], s37 offen lds
    s_add_u32 m0, s27, 2048
    s_add_u32 s31, s25, 16384
    buffer_load_dwordx4 v1, s[4:7], s31 offen lds
    s_add_u32 m0, s27, 18432
    s_add_u32 s37, s26, 28672
    buffer_load_dwordx4 v2, s[8:11], s37 offen lds
    s_add_u32 m0, s27, 3072
    s_add_u32 s31, s25, 16384
    buffer_load_dwordx4 v3, s[4:7], s31 offen lds
    s_add_u32 m0, s27, 19456
    s_add_u32 s37, s26, 43008
    buffer_load_dwordx4 v2, s[8:11], s37 offen lds
    v_and_b32 v28, 31, v0
    v_lshrrev_b32 v29, 5, v0
    v_bfe_u32 v30, v0, 1, 3
    v_xor_b32 v30, v30, v29
    s_lshl_b32 s31, s34, 1
    v_xor_b32 v30, s31, v30
    v_lshlrev_b32 v4, 7, v28
    v_lshl_add_u32 v4, v30, 4, v4
    s_lshl_b32 s28, s34, 13
    v_add_u32 v4, s28, v4
    v_xor_b32 v5, 32, v4
    v_xor_b32 v6, 64, v4
    v_xor_b32 v7, 96, v4
    v_lshlrev_b32 v22, 3, v0
    v_bfe_u32 v30, v0, 2, 2
    v_lshl_add_u32 v8, v29, 3, v30
    v_lshlrev_b32 v8, 8, v8
    v_bfe_u32 v31, v0, 4, 1
    v_lshl_add_u32 v8, v31, 5, v8
    v_and_b32 v31, 3, v0
    v_lshl_add_u32 v8, v31, 3, v8
    s_lshl_b32 s31, s35, 1
    v_xor_b32 v30, s31, v30
    v_lshl_add_u32 v8, v30, 6, v8
    s_lshl_b32 s31, s34, 12
    s_add_u32 s31, s31, 16384
    v_add_u32 v8, s31, v8
    v_xor_b32 v9, 64, v8
    v_xor_b32 v10, 4096, v8
    v_xor_b32 v11, 4160, v8
    v_xor_b32 v12, 8192, v8
    v_xor_b32 v13, 8256, v8
    v_xor_b32 v14, 12288, v8
    v_xor_b32 v15, 12352, v8
    v_mov_b32 v16, 0x3f803f80
    v_mov_b32 v17, 0x3f803f80
    v_lshlrev_b32 v18, 4, v0
    s_lshl_b32 s33, s21, 1
    s_add_u32 s33, s33, s34
    s_lshl_b32 s36, s33, 9
    s_add_u32 s36, s36, 65536
    s_mul_i32 s32, s33, 229376
    s_lshl_b32 s28, s22, 1
    s_add_u32 s28, s28, s35
    s_lshl_b32 s29, s28, 12
    s_add_u32 s32, s32, s29
    s_add_u32 s32, s32, 1048576
    s_add_u32 s38, s32, 114688
    s_mul_i32 s29, s28, 37
    s_lshr_b32 s29, s29, 8
    s_lshl_b32 s33, s33, 2
    s_add_u32 s33, s33, s29
    s_lshl_b32 s33, s33, 7
    s_mul_i32 s29, s29, 7
    s_sub_u32 s29, s28, s29
    s_lshl_b32 s29, s29, 2
    s_add_u32 s33, s33, s29
    s_add_u32 s33, s33, 131072
    s_lshl_b32 s29, s20, 8
    v_lshl_add_u32 v20, v0, 2, s29
    v_add_u32 v20, 157696, v20
    v_xor_b32 v21, 256, v20
    s_mov_b32 s16, s46
    s_mov_b32 s17, s47
    s_mov_b32 s18, 3584
    s_mov_b32 s19, 0x00020000
    v_mov_b32 v19, 0
    v_lshlrev_b32 v28, 1, v0
    s_lshl_b32 s28, s28, 7
    buffer_load_short_d16_hi v19, v28, s[16:19], s28 offen
    v_mov_b32 v192, 0
    v_mov_b32 v193, 0
    v_mov_b32 v194, 0
    v_mov_b32 v195, 0
    v_mov_b32 v196, 0
    v_mov_b32 v197, 0
    v_mov_b32 v198, 0
    v_mov_b32 v199, 0
    v_mov_b32 v200, 0
    v_mov_b32 v201, 0
    v_mov_b32 v202, 0
    v_mov_b32 v203, 0
    v_mov_b32 v204, 0
    v_mov_b32 v205, 0
    v_mov_b32 v206, 0
    v_mov_b32 v207, 0
    v_mov_b32 v208, 0
    v_mov_b32 v209, 0
    v_mov_b32 v210, 0
    v_mov_b32 v211, 0
    v_add_u32 v152, 0x10000, v4
    v_add_u32 v153, 0x10000, v5
    v_add_u32 v154, 0x10000, v6
    v_add_u32 v155, 0x10000, v7
    v_add_u32 v156, 0x10000, v8
    v_add_u32 v157, 0x10000, v9
    v_add_u32 v158, 0x10000, v10
    v_add_u32 v159, 0x10000, v11
    v_add_u32 v160, 0x10000, v12
    v_add_u32 v161, 0x10000, v13
    v_add_u32 v162, 0x10000, v14
    v_add_u32 v163, 0x10000, v15
    s_add_u32 m0, s27, 32768
    s_add_u32 s31, s25, 128
    buffer_load_dwordx4 v1, s[4:7], s31 offen lds
    s_add_u32 m0, s27, 49152
    s_add_u32 s37, s26, 229376
    buffer_load_dwordx4 v2, s[8:11], s37 offen lds
    s_add_u32 m0, s27, 33792
    s_add_u32 s31, s25, 128
    buffer_load_dwordx4 v3, s[4:7], s31 offen lds
    s_add_u32 m0, s27, 50176
    s_add_u32 s37, s26, 243712
    buffer_load_dwordx4 v2, s[8:11], s37 offen lds
    s_add_u32 m0, s27, 34816
    s_add_u32 s31, s25, 16512
    buffer_load_dwordx4 v1, s[4:7], s31 offen lds
    s_add_u32 m0, s27, 51200
    s_add_u32 s37, s26, 258048
    buffer_load_dwordx4 v2, s[8:11], s37 offen lds
    s_add_u32 m0, s27, 35840
    s_add_u32 s31, s25, 16512
    buffer_load_dwordx4 v3, s[4:7], s31 offen lds
    s_add_u32 m0, s27, 52224
    s_add_u32 s37, s26, 272384
    buffer_load_dwordx4 v2, s[8:11], s37 offen lds
    s_barrier
    s_add_u32 m0, s27, 65536
    s_add_u32 s31, s25, 256
    buffer_load_dwordx4 v1, s[4:7], s31 offen lds
    s_add_u32 m0, s27, 81920
    s_add_u32 s37, s26, 458752
    buffer_load_dwordx4 v2, s[8:11], s37 offen lds
    s_add_u32 m0, s27, 66560
    s_add_u32 s31, s25, 256
    buffer_load_dwordx4 v3, s[4:7], s31 offen lds
    s_add_u32 m0, s27, 82944
    s_add_u32 s37, s26, 473088
    buffer_load_dwordx4 v2, s[8:11], s37 offen lds
    s_add_u32 m0, s27, 67584
    s_add_u32 s31, s25, 16640
    buffer_load_dwordx4 v1, s[4:7], s31 offen lds
    s_add_u32 m0, s27, 83968
    s_add_u32 s37, s26, 487424
    buffer_load_dwordx4 v2, s[8:11], s37 offen lds
    s_add_u32 m0, s27, 68608
    s_add_u32 s31, s25, 16640
    buffer_load_dwordx4 v3, s[4:7], s31 offen lds
    s_add_u32 m0, s27, 84992
    s_add_u32 s37, s26, 501760
    buffer_load_dwordx4 v2, s[8:11], s37 offen lds
    s_mov_b32 s16, s48
    s_mov_b32 s17, s49
    s_mov_b32 s18, 1835008
    s_mov_b32 s19, 0x00020000
    s_lshl_b32 s28, s24, 2
    s_add_u32 s28, s28, s39
    s_mul_i32 s30, s28, 40
    v_add_u32 v28, s30, v0
    v_mul_u32_u24 v29, 0x4925, v28
    v_lshrrev_b32 v29, 18, v29
    v_mul_u32_u24 v30, 14, v29
    v_sub_u32 v28, v28, v30
    v_lshlrev_b32 v28, 7, v28
    v_mul_u32_u24 v29, 3584, v29
    v_add_u32 v28, v28, v29
    s_mul_i32 s30, s28, 23
    v_add_u32 v29, s30, v0
    v_min_u32 v29, 2559, v29
    v_mul_u32_u24 v30, 13108, v29
    v_lshrrev_b32 v30, 16, v30
    v_mul_u32_u24 v31, 3, v30
    v_add_u32 v29, v29, v31
    v_lshlrev_b32 v29, 7, v29
    v_lshlrev_b32 v30, 7, v0
    s_and_b32 s29, s23, 1
    s_mul_i32 s29, s29, 1792
    s_add_u32 s29, s29, 688128
    s_mov_b32 exec_hi, 255
    s_mov_b32 exec_lo, -1
    buffer_load_dword v252, v28, s[8:11], s29 offen
    s_lshr_b32 s29, s23, 1
    s_lshl_b32 s29, s29, 19
    s_add_u32 s29, s29, 384
    s_mov_b64 exec, 0x7fffff
    buffer_load_dword v252, v29, s[4:7], s29 offen
    s_lshl_b32 s28, s2, 2
    s_add_u32 s28, s28, s39
    s_lshl_b32 s28, s28, 11
    s_mov_b64 exec, 1
    buffer_load_dword v252, v30, s[16:19], s28 offen
    s_mov_b64 exec, -1
    v_lshlrev_b32 v30, 20, v0
    s_mov_b64 exec, 1
    global_load_dword v252, v30, s[50:51]
    s_mov_b64 exec, -1
    v_lshrrev_b32 v28, 3, v0
    v_and_b32 v29, 7, v0
    v_lshlrev_b32 v28, 13, v28
    v_lshl_add_u32 v28, v29, 4, v28
    s_lshr_b32 s28, s39, 1
    s_lshl_b32 s31, s2, 1
    s_add_u32 s31, s31, s28
    s_lshr_b32 s29, s31, 6
    s_lshl_b32 s29, s29, 18
    s_and_b32 s28, s31, 63
    s_lshl_b32 s28, s28, 7
    s_add_u32 s29, s29, s28
    s_add_u32 s29, s29, 12582912
    s_and_b32 s30, s39, 1
    s_lshl_b32 s30, s30, 17
    s_add_u32 s30, s30, s29
    s_add_u32 s31, s30, 65536
    v_mov_b32 v180, -1
    v_mov_b32 v181, -1
    v_mov_b32 v182, -1
    v_mov_b32 v183, -1
    buffer_store_dwordx4 v[180:183], v28, s[12:15], s30 offen sc1
    buffer_store_dwordx4 v[180:183], v28, s[12:15], s31 offen sc1
    s_mov_b32 s16, s48
    s_mov_b32 s17, s49
    s_mov_b32 s18, 1835008
    s_mov_b32 s19, 0x00020000
    v_lshrrev_b32 v28, 2, v0
    v_and_b32 v28, 4, v28
    v_and_b32 v29, 7, v0
    v_xor_b32 v28, v28, v29
    v_lshrrev_b32 v29, 3, v0
    v_lshlrev_b32 v23, 10, v29
    v_lshl_add_u32 v23, v28, 4, v23
    s_mul_i32 s72, s39, 458752
    s_lshl_b32 s75, s79, 7
    s_add_u32 s72, s72, s75
    s_lshl_b32 s73, s39, 13
    v_lshrrev_b32 v29, 5, v0
    v_bfe_u32 v28, v0, 2, 2
    v_lshl_add_u32 v24, v29, 2, v28
    v_lshlrev_b32 v24, 7, v24
    v_bfe_u32 v28, v0, 4, 1
    v_lshl_add_u32 v24, v28, 5, v24
    v_and_b32 v28, 3, v0
    v_lshl_add_u32 v24, v28, 3, v24
    v_bfe_u32 v28, v0, 3, 1
    v_lshl_add_u32 v24, v28, 6, v24
    v_add_u32 v24, s73, v24
    v_xor_b32 v25, 64, v24
    v_add_u32 v26, 0x10000, v24
    v_add_u32 v27, 0x10000, v25
    s_waitcnt vmcnt(23) lgkmcnt(0)
    s_barrier
    ds_read_b128 v[56:59], v4 offset:0
    ds_read_b64_tr_b16 v[32:33], v8 offset:0
    ds_read_b64_tr_b16 v[34:35], v8 offset:1024
    ds_read_b64_tr_b16 v[36:37], v9 offset:0
    ds_read_b64_tr_b16 v[38:39], v9 offset:1024
    ds_read_b128 v[60:63], v4 offset:4096
    ds_read_b128 v[64:67], v5 offset:0
    ds_read_b64_tr_b16 v[40:41], v10 offset:0
    ds_read_b64_tr_b16 v[42:43], v10 offset:1024
    ds_read_b64_tr_b16 v[44:45], v11 offset:0
    ds_read_b64_tr_b16 v[46:47], v11 offset:1024
    ds_read_b128 v[68:71], v5 offset:4096
    s_mul_i32 s76, s76, 0x9E3779B1
    s_add_u32 s76, s76, 0x7F4A7C15
    s_waitcnt lgkmcnt(6)
    v_mfma_f32_32x32x16_bf16 v[80:95], v[32:35], v[56:59], 0
    ds_read_b128 v[72:75], v6 offset:0
    ds_read_b64_tr_b16 v[48:49], v12 offset:0
    v_mfma_f32_32x32x16_bf16 v[96:111], v[36:39], v[56:59], 0
    ds_read_b64_tr_b16 v[50:51], v12 offset:1024
    ds_read_b64_tr_b16 v[52:53], v13 offset:0
    v_mfma_f32_4x4x4_16b_bf16 v[144:147], v[16:17], v[32:33], 0
    v_mfma_f32_4x4x4_16b_bf16 v[148:151], v[16:17], v[36:37], 0
    v_mfma_f32_32x32x16_bf16 v[112:127], v[32:35], v[60:63], 0
    ds_read_b64_tr_b16 v[54:55], v13 offset:1024
    ds_read_b128 v[76:79], v6 offset:4096
    v_mfma_f32_32x32x16_bf16 v[128:143], v[36:39], v[60:63], 0
    v_mfma_f32_4x4x4_16b_bf16 v[144:147], v[16:17], v[34:35], v[144:147]
    v_mfma_f32_4x4x4_16b_bf16 v[148:151], v[16:17], v[38:39], v[148:151]
    s_waitcnt lgkmcnt(6)
    v_mfma_f32_32x32x16_bf16 v[80:95], v[40:43], v[64:67], v[80:95]
    ds_read_b128 v[56:59], v7 offset:0
    ds_read_b64_tr_b16 v[32:33], v14 offset:0
    v_mfma_f32_32x32x16_bf16 v[96:111], v[44:47], v[64:67], v[96:111]
    ds_read_b64_tr_b16 v[34:35], v14 offset:1024
    ds_read_b64_tr_b16 v[36:37], v15 offset:0
    v_mfma_f32_32x32x16_bf16 v[112:127], v[40:43], v[68:71], v[112:127]
    ds_read_b64_tr_b16 v[38:39], v15 offset:1024
    ds_read_b128 v[60:63], v7 offset:4096
    v_mfma_f32_32x32x16_bf16 v[128:143], v[44:47], v[68:71], v[128:143]
    s_waitcnt lgkmcnt(6)
    v_mfma_f32_32x32x16_bf16 v[80:95], v[48:51], v[72:75], v[80:95]
    s_waitcnt vmcnt(14)
    s_barrier
    ds_read_b128 v[64:67], v4 offset:32768
    ds_read_b64_tr_b16 v[40:41], v8 offset:32768
    v_mfma_f32_32x32x16_bf16 v[96:111], v[52:55], v[72:75], v[96:111]
    ds_read_b64_tr_b16 v[42:43], v8 offset:33792
    ds_read_b64_tr_b16 v[44:45], v9 offset:32768
    v_mfma_f32_4x4x4_16b_bf16 v[144:147], v[16:17], v[48:49], v[144:147]
    v_mfma_f32_4x4x4_16b_bf16 v[148:151], v[16:17], v[52:53], v[148:151]
    v_mfma_f32_32x32x16_bf16 v[112:127], v[48:51], v[76:79], v[112:127]
    ds_read_b64_tr_b16 v[46:47], v9 offset:33792
    ds_read_b128 v[68:71], v4 offset:36864
    v_mfma_f32_32x32x16_bf16 v[128:143], v[52:55], v[76:79], v[128:143]
    v_mfma_f32_4x4x4_16b_bf16 v[144:147], v[16:17], v[50:51], v[144:147]
    v_mfma_f32_4x4x4_16b_bf16 v[148:151], v[16:17], v[54:55], v[148:151]
    s_waitcnt lgkmcnt(6)
    v_mfma_f32_32x32x16_bf16 v[80:95], v[32:35], v[56:59], v[80:95]
    ds_read_b128 v[72:75], v5 offset:32768
    ds_read_b64_tr_b16 v[48:49], v10 offset:32768
    v_mfma_f32_32x32x16_bf16 v[96:111], v[36:39], v[56:59], v[96:111]
    ds_read_b64_tr_b16 v[50:51], v10 offset:33792
    ds_read_b64_tr_b16 v[52:53], v11 offset:32768
    v_mfma_f32_32x32x16_bf16 v[112:127], v[32:35], v[60:63], v[112:127]
    ds_read_b64_tr_b16 v[54:55], v11 offset:33792
    ds_read_b128 v[76:79], v5 offset:36864
    v_mfma_f32_32x32x16_bf16 v[128:143], v[36:39], v[60:63], v[128:143]
    s_waitcnt lgkmcnt(6)
    v_mfma_f32_32x32x16_bf16 v[80:95], v[40:43], v[64:67], v[80:95]
    ds_read_b128 v[56:59], v6 offset:32768
    ds_read_b64_tr_b16 v[32:33], v12 offset:32768
    v_mfma_f32_32x32x16_bf16 v[96:111], v[44:47], v[64:67], v[96:111]
    ds_read_b64_tr_b16 v[34:35], v12 offset:33792
    ds_read_b64_tr_b16 v[36:37], v13 offset:32768
    v_mfma_f32_4x4x4_16b_bf16 v[144:147], v[16:17], v[40:41], v[144:147]
    v_mfma_f32_4x4x4_16b_bf16 v[148:151], v[16:17], v[44:45], v[148:151]
    v_mfma_f32_32x32x16_bf16 v[112:127], v[40:43], v[68:71], v[112:127]
    ds_read_b64_tr_b16 v[38:39], v13 offset:33792
    ds_read_b128 v[60:63], v6 offset:36864
    v_mfma_f32_32x32x16_bf16 v[128:143], v[44:47], v[68:71], v[128:143]
    v_mfma_f32_4x4x4_16b_bf16 v[144:147], v[16:17], v[42:43], v[144:147]
    v_mfma_f32_4x4x4_16b_bf16 v[148:151], v[16:17], v[46:47], v[148:151]
    s_waitcnt lgkmcnt(6)
    v_mfma_f32_32x32x16_bf16 v[80:95], v[48:51], v[72:75], v[80:95]
    ds_read_b128 v[64:67], v7 offset:32768
    ds_read_b64_tr_b16 v[40:41], v14 offset:32768
    v_mfma_f32_32x32x16_bf16 v[96:111], v[52:55], v[72:75], v[96:111]
    ds_read_b64_tr_b16 v[42:43], v14 offset:33792
    ds_read_b64_tr_b16 v[44:45], v15 offset:32768
    v_mfma_f32_32x32x16_bf16 v[112:127], v[48:51], v[76:79], v[112:127]
    ds_read_b64_tr_b16 v[46:47], v15 offset:33792
    ds_read_b128 v[68:71], v7 offset:36864
    v_mfma_f32_32x32x16_bf16 v[128:143], v[52:55], v[76:79], v[128:143]
    s_xor_b32 s28, s2, 0
    s_lshl_b32 s28, s28, 2
    s_add_u32 s28, s28, s39
    s_lshl_b32 s28, s28, 11
    v_lshlrev_b32 v30, 7, v0
    s_mov_b64 exec, 0xffff
    buffer_load_dword v252, v30, s[16:19], s28 offen
    s_mov_b64 exec, -1
    s_waitcnt lgkmcnt(6)
    v_mfma_f32_32x32x16_bf16 v[80:95], v[32:35], v[56:59], v[80:95]
    s_waitcnt vmcnt(7)
    s_barrier
    ds_read_b128 v[72:75], v152 offset:0
    ds_read_b64_tr_b16 v[48:49], v156 offset:0
    v_mfma_f32_32x32x16_bf16 v[96:111], v[36:39], v[56:59], v[96:111]
    ds_read_b64_tr_b16 v[50:51], v156 offset:1024
    ds_read_b64_tr_b16 v[52:53], v157 offset:0
    v_mfma_f32_4x4x4_16b_bf16 v[144:147], v[16:17], v[32:33], v[144:147]
    v_mfma_f32_4x4x4_16b_bf16 v[148:151], v[16:17], v[36:37], v[148:151]
    v_mfma_f32_32x32x16_bf16 v[112:127], v[32:35], v[60:63], v[112:127]
    ds_read_b64_tr_b16 v[54:55], v157 offset:1024
    ds_read_b128 v[76:79], v152 offset:4096
    v_mfma_f32_32x32x16_bf16 v[128:143], v[36:39], v[60:63], v[128:143]
    v_mfma_f32_4x4x4_16b_bf16 v[144:147], v[16:17], v[34:35], v[144:147]
    v_mfma_f32_4x4x4_16b_bf16 v[148:151], v[16:17], v[38:39], v[148:151]
    s_waitcnt lgkmcnt(6)
    v_mfma_f32_32x32x16_bf16 v[80:95], v[40:43], v[64:67], v[80:95]
    ds_read_b128 v[56:59], v153 offset:0
    ds_read_b64_tr_b16 v[32:33], v158 offset:0
    v_mfma_f32_32x32x16_bf16 v[96:111], v[44:47], v[64:67], v[96:111]
    ds_read_b64_tr_b16 v[34:35], v158 offset:1024
    ds_read_b64_tr_b16 v[36:37], v159 offset:0
    v_mfma_f32_32x32x16_bf16 v[112:127], v[40:43], v[68:71], v[112:127]
    ds_read_b64_tr_b16 v[38:39], v159 offset:1024
    ds_read_b128 v[60:63], v153 offset:4096
    v_mfma_f32_32x32x16_bf16 v[128:143], v[44:47], v[68:71], v[128:143]
    s_waitcnt lgkmcnt(6)
    v_mfma_f32_32x32x16_bf16 v[80:95], v[48:51], v[72:75], v[80:95]
    ds_read_b128 v[64:67], v154 offset:0
    ds_read_b64_tr_b16 v[40:41], v160 offset:0
    v_mfma_f32_32x32x16_bf16 v[96:111], v[52:55], v[72:75], v[96:111]
    ds_read_b64_tr_b16 v[42:43], v160 offset:1024
    ds_read_b64_tr_b16 v[44:45], v161 offset:0
    v_mfma_f32_4x4x4_16b_bf16 v[144:147], v[16:17], v[48:49], v[144:147]
    v_mfma_f32_4x4x4_16b_bf16 v[148:151], v[16:17], v[52:53], v[148:151]
    v_mfma_f32_32x32x16_bf16 v[112:127], v[48:51], v[76:79], v[112:127]
    ds_read_b64_tr_b16 v[46:47], v161 offset:1024
    ds_read_b128 v[68:71], v154 offset:4096
    v_mfma_f32_32x32x16_bf16 v[128:143], v[52:55], v[76:79], v[128:143]
    v_mfma_f32_4x4x4_16b_bf16 v[144:147], v[16:17], v[50:51], v[144:147]
    v_mfma_f32_4x4x4_16b_bf16 v[148:151], v[16:17], v[54:55], v[148:151]
    s_waitcnt lgkmcnt(6)
    v_mfma_f32_32x32x16_bf16 v[80:95], v[32:35], v[56:59], v[80:95]
    ds_read_b128 v[72:75], v155 offset:0
    ds_read_b64_tr_b16 v[48:49], v162 offset:0
    v_mfma_f32_32x32x16_bf16 v[96:111], v[36:39], v[56:59], v[96:111]
    ds_read_b64_tr_b16 v[50:51], v162 offset:1024
    ds_read_b64_tr_b16 v[52:53], v163 offset:0
    v_mfma_f32_32x32x16_bf16 v[112:127], v[32:35], v[60:63], v[112:127]
    ds_read_b64_tr_b16 v[54:55], v163 offset:1024
    ds_read_b128 v[76:79], v155 offset:4096
    v_mfma_f32_32x32x16_bf16 v[128:143], v[36:39], v[60:63], v[128:143]
    s_waitcnt lgkmcnt(6)
    v_mfma_f32_32x32x16_bf16 v[80:95], v[40:43], v[64:67], v[80:95]
    s_barrier
    ds_read_b128 v[56:59], v152 offset:32768
    ds_read_b64_tr_b16 v[32:33], v156 offset:32768
    v_mfma_f32_32x32x16_bf16 v[96:111], v[44:47], v[64:67], v[96:111]
    ds_read_b64_tr_b16 v[34:35], v156 offset:33792
    ds_read_b64_tr_b16 v[36:37], v157 offset:32768
    v_mfma_f32_4x4x4_16b_bf16 v[144:147], v[16:17], v[40:41], v[144:147]
    v_mfma_f32_4x4x4_16b_bf16 v[148:151], v[16:17], v[44:45], v[148:151]
    v_mfma_f32_32x32x16_bf16 v[112:127], v[40:43], v[68:71], v[112:127]
    ds_read_b64_tr_b16 v[38:39], v157 offset:33792
    ds_read_b128 v[60:63], v152 offset:36864
    v_mfma_f32_32x32x16_bf16 v[128:143], v[44:47], v[68:71], v[128:143]
    v_mfma_f32_4x4x4_16b_bf16 v[144:147], v[16:17], v[42:43], v[144:147]
    v_mfma_f32_4x4x4_16b_bf16 v[148:151], v[16:17], v[46:47], v[148:151]
    s_waitcnt lgkmcnt(6)
    v_mfma_f32_32x32x16_bf16 v[80:95], v[48:51], v[72:75], v[80:95]
    ds_read_b128 v[64:67], v153 offset:32768
    ds_read_b64_tr_b16 v[40:41], v158 offset:32768
    v_mfma_f32_32x32x16_bf16 v[96:111], v[52:55], v[72:75], v[96:111]
    ds_read_b64_tr_b16 v[42:43], v158 offset:33792
    ds_read_b64_tr_b16 v[44:45], v159 offset:32768
    v_mfma_f32_32x32x16_bf16 v[112:127], v[48:51], v[76:79], v[112:127]
    ds_read_b64_tr_b16 v[46:47], v159 offset:33792
    ds_read_b128 v[68:71], v153 offset:36864
    v_mfma_f32_32x32x16_bf16 v[128:143], v[52:55], v[76:79], v[128:143]
    s_waitcnt lgkmcnt(6)
    v_mfma_f32_32x32x16_bf16 v[80:95], v[32:35], v[56:59], v[80:95]
    ds_read_b128 v[72:75], v154 offset:32768
    ds_read_b64_tr_b16 v[48:49], v160 offset:32768
    v_mfma_f32_32x32x16_bf16 v[96:111], v[36:39], v[56:59], v[96:111]
    ds_read_b64_tr_b16 v[50:51], v160 offset:33792
    ds_read_b64_tr_b16 v[52:53], v161 offset:32768
    v_mfma_f32_4x4x4_16b_bf16 v[144:147], v[16:17], v[32:33], v[144:147]
    v_mfma_f32_4x4x4_16b_bf16 v[148:151], v[16:17], v[36:37], v[148:151]
    v_mfma_f32_32x32x16_bf16 v[112:127], v[32:35], v[60:63], v[112:127]
    ds_read_b64_tr_b16 v[54:55], v161 offset:33792
    ds_read_b128 v[76:79], v154 offset:36864
    v_mfma_f32_32x32x16_bf16 v[128:143], v[36:39], v[60:63], v[128:143]
    v_mfma_f32_4x4x4_16b_bf16 v[144:147], v[16:17], v[34:35], v[144:147]
    v_mfma_f32_4x4x4_16b_bf16 v[148:151], v[16:17], v[38:39], v[148:151]
    s_waitcnt lgkmcnt(6)
    v_mfma_f32_32x32x16_bf16 v[80:95], v[40:43], v[64:67], v[80:95]
    ds_read_b128 v[56:59], v155 offset:32768
    ds_read_b64_tr_b16 v[32:33], v162 offset:32768
    v_mfma_f32_32x32x16_bf16 v[96:111], v[44:47], v[64:67], v[96:111]
    ds_read_b64_tr_b16 v[34:35], v162 offset:33792
    ds_read_b64_tr_b16 v[36:37], v163 offset:32768
    v_mfma_f32_32x32x16_bf16 v[112:127], v[40:43], v[68:71], v[112:127]
    ds_read_b64_tr_b16 v[38:39], v163 offset:33792
    ds_read_b128 v[60:63], v155 offset:36864
    v_mfma_f32_32x32x16_bf16 v[128:143], v[44:47], v[68:71], v[128:143]
    s_waitcnt lgkmcnt(6)
    v_mfma_f32_32x32x16_bf16 v[80:95], v[48:51], v[72:75], v[80:95]
    s_barrier
    ds_read_b128 v[64:67], v4 offset:0
    ds_read_b64_tr_b16 v[40:41], v8 offset:0
    v_mfma_f32_32x32x16_bf16 v[96:111], v[52:55], v[72:75], v[96:111]
    ds_read_b64_tr_b16 v[42:43], v8 offset:1024
    ds_read_b64_tr_b16 v[44:45], v9 offset:0
    v_mfma_f32_4x4x4_16b_bf16 v[144:147], v[16:17], v[48:49], v[144:147]
    v_mfma_f32_4x4x4_16b_bf16 v[148:151], v[16:17], v[52:53], v[148:151]
    v_mfma_f32_32x32x16_bf16 v[112:127], v[48:51], v[76:79], v[112:127]
    ds_read_b64_tr_b16 v[46:47], v9 offset:1024
    ds_read_b128 v[68:71], v4 offset:4096
    v_mfma_f32_32x32x16_bf16 v[128:143], v[52:55], v[76:79], v[128:143]
    v_mfma_f32_4x4x4_16b_bf16 v[144:147], v[16:17], v[50:51], v[144:147]
    v_mfma_f32_4x4x4_16b_bf16 v[148:151], v[16:17], v[54:55], v[148:151]
    s_waitcnt lgkmcnt(6)
    v_mfma_f32_32x32x16_bf16 v[80:95], v[32:35], v[56:59], v[80:95]
    ds_read_b128 v[72:75], v5 offset:0
    ds_read_b64_tr_b16 v[48:49], v10 offset:0
    v_mfma_f32_32x32x16_bf16 v[96:111], v[36:39], v[56:59], v[96:111]
    ds_read_b64_tr_b16 v[50:51], v10 offset:1024
    ds_read_b64_tr_b16 v[52:53], v11 offset:0
    v_mfma_f32_32x32x16_bf16 v[112:127], v[32:35], v[60:63], v[112:127]
    ds_read_b64_tr_b16 v[54:55], v11 offset:1024
    ds_read_b128 v[76:79], v5 offset:4096
    v_mfma_f32_32x32x16_bf16 v[128:143], v[36:39], v[60:63], v[128:143]
    s_lshr_b32 s28, s39, 1
    s_lshl_b32 s29, s2, 1
    s_add_u32 s28, s28, s29
    s_and_b32 s29, s39, 1
    s_lshl_b32 s29, s29, 9
    s_add_u32 s28, s28, s29
    s_lshl_b32 s28, s28, 2
    s_add_u32 s28, s28, 262144
    s_waitcnt lgkmcnt(6)
    v_mfma_f32_32x32x16_bf16 v[80:95], v[40:43], v[64:67], v[80:95]
    ds_read_b128 v[56:59], v6 offset:0
    ds_read_b64_tr_b16 v[32:33], v12 offset:0
    v_mfma_f32_32x32x16_bf16 v[96:111], v[44:47], v[64:67], v[96:111]
    ds_read_b64_tr_b16 v[34:35], v12 offset:1024
    ds_read_b64_tr_b16 v[36:37], v13 offset:0
    v_mfma_f32_4x4x4_16b_bf16 v[144:147], v[16:17], v[40:41], v[144:147]
    v_mfma_f32_4x4x4_16b_bf16 v[148:151], v[16:17], v[44:45], v[148:151]
    v_mfma_f32_32x32x16_bf16 v[112:127], v[40:43], v[68:71], v[112:127]
    ds_read_b64_tr_b16 v[38:39], v13 offset:1024
    ds_read_b128 v[60:63], v6 offset:4096
    v_mfma_f32_32x32x16_bf16 v[128:143], v[44:47], v[68:71], v[128:143]
    s_waitcnt vmcnt(0)
    v_mov_b32 v28, 0
    v_mov_b32 v29, s76
    s_mov_b64 exec, 1
    buffer_store_dword v29, v28, s[12:15], s28 offen sc1
    s_mov_b64 exec, -1
    v_mfma_f32_4x4x4_16b_bf16 v[144:147], v[16:17], v[42:43], v[144:147]
    v_mfma_f32_4x4x4_16b_bf16 v[148:151], v[16:17], v[46:47], v[148:151]
    s_waitcnt lgkmcnt(6)
    v_mfma_f32_32x32x16_bf16 v[80:95], v[48:51], v[72:75], v[80:95]
    ds_read_b128 v[64:67], v7 offset:0
    ds_read_b64_tr_b16 v[40:41], v14 offset:0
    v_mfma_f32_32x32x16_bf16 v[96:111], v[52:55], v[72:75], v[96:111]
    ds_read_b64_tr_b16 v[42:43], v14 offset:1024
    ds_read_b64_tr_b16 v[44:45], v15 offset:0
    v_mfma_f32_32x32x16_bf16 v[112:127], v[48:51], v[76:79], v[112:127]
    ds_read_b64_tr_b16 v[46:47], v15 offset:1024
    ds_read_b128 v[68:71], v7 offset:4096
    v_mfma_f32_32x32x16_bf16 v[128:143], v[52:55], v[76:79], v[128:143]
    s_waitcnt lgkmcnt(6)
    v_mfma_f32_32x32x16_bf16 v[80:95], v[32:35], v[56:59], v[80:95]
    s_barrier
    ds_read_b128 v[72:75], v4 offset:32768
    ds_read_b64_tr_b16 v[48:49], v8 offset:32768
    v_mfma_f32_32x32x16_bf16 v[96:111], v[36:39], v[56:59], v[96:111]
    ds_read_b64_tr_b16 v[50:51], v8 offset:33792
    ds_read_b64_tr_b16 v[52:53], v9 offset:32768
    v_mfma_f32_4x4x4_16b_bf16 v[144:147], v[16:17], v[32:33], v[144:147]
    v_mfma_f32_4x4x4_16b_bf16 v[148:151], v[16:17], v[36:37], v[148:151]
    v_mfma_f32_32x32x16_bf16 v[112:127], v[32:35], v[60:63], v[112:127]
    ds_read_b64_tr_b16 v[54:55], v9 offset:33792
    ds_read_b128 v[76:79], v4 offset:36864
    v_mfma_f32_32x32x16_bf16 v[128:143], v[36:39], v[60:63], v[128:143]
    v_mfma_f32_4x4x4_16b_bf16 v[144:147], v[16:17], v[34:35], v[144:147]
    v_mfma_f32_4x4x4_16b_bf16 v[148:151], v[16:17], v[38:39], v[148:151]
    s_waitcnt lgkmcnt(6)
    v_mfma_f32_32x32x16_bf16 v[80:95], v[40:43], v[64:67], v[80:95]
    ds_read_b128 v[56:59], v5 offset:32768
    ds_read_b64_tr_b16 v[32:33], v10 offset:32768
    v_mfma_f32_32x32x16_bf16 v[96:111], v[44:47], v[64:67], v[96:111]
    ds_read_b64_tr_b16 v[34:35], v10 offset:33792
    ds_read_b64_tr_b16 v[36:37], v11 offset:32768
    v_mfma_f32_32x32x16_bf16 v[112:127], v[40:43], v[68:71], v[112:127]
    ds_read_b64_tr_b16 v[38:39], v11 offset:33792
    ds_read_b128 v[60:63], v5 offset:36864
    v_mfma_f32_32x32x16_bf16 v[128:143], v[44:47], v[68:71], v[128:143]
    s_waitcnt lgkmcnt(6)
    v_mfma_f32_32x32x16_bf16 v[80:95], v[48:51], v[72:75], v[80:95]
    ds_read_b128 v[64:67], v6 offset:32768
    ds_read_b64_tr_b16 v[40:41], v12 offset:32768
    v_mfma_f32_32x32x16_bf16 v[96:111], v[52:55], v[72:75], v[96:111]
    ds_read_b64_tr_b16 v[42:43], v12 offset:33792
    ds_read_b64_tr_b16 v[44:45], v13 offset:32768
    v_mfma_f32_4x4x4_16b_bf16 v[144:147], v[16:17], v[48:49], v[144:147]
    v_mfma_f32_4x4x4_16b_bf16 v[148:151], v[16:17], v[52:53], v[148:151]
    v_mfma_f32_32x32x16_bf16 v[112:127], v[48:51], v[76:79], v[112:127]
    ds_read_b64_tr_b16 v[46:47], v13 offset:33792
    ds_read_b128 v[68:71], v6 offset:36864
    v_mfma_f32_32x32x16_bf16 v[128:143], v[52:55], v[76:79], v[128:143]
    v_mfma_f32_4x4x4_16b_bf16 v[144:147], v[16:17], v[50:51], v[144:147]
    v_mfma_f32_4x4x4_16b_bf16 v[148:151], v[16:17], v[54:55], v[148:151]
    s_waitcnt lgkmcnt(6)
    v_mfma_f32_32x32x16_bf16 v[80:95], v[32:35], v[56:59], v[80:95]
    ds_read_b128 v[72:75], v7 offset:32768
    ds_read_b64_tr_b16 v[48:49], v14 offset:32768
    v_mfma_f32_32x32x16_bf16 v[96:111], v[36:39], v[56:59], v[96:111]
    ds_read_b64_tr_b16 v[50:51], v14 offset:33792
    ds_read_b64_tr_b16 v[52:53], v15 offset:32768
    v_mfma_f32_32x32x16_bf16 v[112:127], v[32:35], v[60:63], v[112:127]
    ds_read_b64_tr_b16 v[54:55], v15 offset:33792
    ds_read_b128 v[76:79], v7 offset:36864
    v_mfma_f32_32x32x16_bf16 v[128:143], v[36:39], v[60:63], v[128:143]
    buffer_load_dwordx2 v[188:189], v22, s[12:15], s36 offen sc1
    s_waitcnt lgkmcnt(6)
    v_mfma_f32_32x32x16_bf16 v[80:95], v[40:43], v[64:67], v[80:95]
    s_barrier
    ds_read_b128 v[56:59], v152 offset:0
    ds_read_b64_tr_b16 v[32:33], v156 offset:0
    v_mfma_f32_32x32x16_bf16 v[96:111], v[44:47], v[64:67], v[96:111]
    ds_read_b64_tr_b16 v[34:35], v156 offset:1024
    ds_read_b64_tr_b16 v[36:37], v157 offset:0
    v_mfma_f32_4x4x4_16b_bf16 v[144:147], v[16:17], v[40:41], v[144:147]
    v_mfma_f32_4x4x4_16b_bf16 v[148:151], v[16:17], v[44:45], v[148:151]
    v_mfma_f32_32x32x16_bf16 v[112:127], v[40:43], v[68:71], v[112:127]
    ds_read_b64_tr_b16 v[38:39], v157 offset:1024
    ds_read_b128 v[60:63], v152 offset:4096
    v_mfma_f32_32x32x16_bf16 v[128:143], v[44:47], v[68:71], v[128:143]
    v_mfma_f32_4x4x4_16b_bf16 v[144:147], v[16:17], v[42:43], v[144:147]
    v_mfma_f32_4x4x4_16b_bf16 v[148:151], v[16:17], v[46:47], v[148:151]
    s_waitcnt lgkmcnt(6)
    v_mfma_f32_32x32x16_bf16 v[80:95], v[48:51], v[72:75], v[80:95]
    ds_read_b128 v[64:67], v153 offset:0
    ds_read_b64_tr_b16 v[40:41], v158 offset:0
    v_mfma_f32_32x32x16_bf16 v[96:111], v[52:55], v[72:75], v[96:111]
    ds_read_b64_tr_b16 v[42:43], v158 offset:1024
    ds_read_b64_tr_b16 v[44:45], v159 offset:0
    v_mfma_f32_32x32x16_bf16 v[112:127], v[48:51], v[76:79], v[112:127]
    ds_read_b64_tr_b16 v[46:47], v159 offset:1024
    ds_read_b128 v[68:71], v153 offset:4096
    v_mfma_f32_32x32x16_bf16 v[128:143], v[52:55], v[76:79], v[128:143]
    v_lshrrev_b32 v28, 3, v0
    v_and_b32 v29, 7, v0
    v_lshlrev_b32 v28, 10, v28
    v_lshlrev_b32 v29, 4, v29
    v_add_u32 v28, v28, v29
    s_lshl_b32 s29, s78, 6
    s_lshl_b32 s28, s20, 3
    s_add_u32 s29, s29, s28
    s_lshl_b32 s29, s29, 10
    s_waitcnt lgkmcnt(6)
    v_mfma_f32_32x32x16_bf16 v[80:95], v[32:35], v[56:59], v[80:95]
    ds_read_b128 v[72:75], v154 offset:0
    ds_read_b64_tr_b16 v[48:49], v160 offset:0
    v_mfma_f32_32x32x16_bf16 v[96:111], v[36:39], v[56:59], v[96:111]
    ds_read_b64_tr_b16 v[50:51], v160 offset:1024
    ds_read_b64_tr_b16 v[52:53], v161 offset:0
    v_mfma_f32_4x4x4_16b_bf16 v[144:147], v[16:17], v[32:33], v[144:147]
    v_mfma_f32_4x4x4_16b_bf16 v[148:151], v[16:17], v[36:37], v[148:151]
    v_mfma_f32_32x32x16_bf16 v[112:127], v[32:35], v[60:63], v[112:127]
    ds_read_b64_tr_b16 v[54:55], v161 offset:1024
    ds_read_b128 v[76:79], v154 offset:4096
    v_mfma_f32_32x32x16_bf16 v[128:143], v[36:39], v[60:63], v[128:143]
    s_lshl_b32 s30, s79, 7
    s_add_u32 s29, s29, s30
    s_mov_b32 s8, s50
    s_mov_b32 s9, s51
    s_mov_b32 s10, 1024
    s_mov_b32 s11, 0x00020000
    buffer_load_dwordx4 v[4:7], v28, s[4:7], s29 offen
    buffer_load_dwordx4 v[8:11], v29, s[8:11], s30 offen
    v_mfma_f32_4x4x4_16b_bf16 v[144:147], v[16:17], v[34:35], v[144:147]
    v_mfma_f32_4x4x4_16b_bf16 v[148:151], v[16:17], v[38:39], v[148:151]
    s_waitcnt lgkmcnt(6)
    v_mfma_f32_32x32x16_bf16 v[80:95], v[40:43], v[64:67], v[80:95]
    ds_read_b128 v[56:59], v155 offset:0
    ds_read_b64_tr_b16 v[32:33], v162 offset:0
    v_mfma_f32_32x32x16_bf16 v[96:111], v[44:47], v[64:67], v[96:111]
    ds_read_b64_tr_b16 v[34:35], v162 offset:1024
    ds_read_b64_tr_b16 v[36:37], v163 offset:0
    v_mfma_f32_32x32x16_bf16 v[112:127], v[40:43], v[68:71], v[112:127]
    ds_read_b64_tr_b16 v[38:39], v163 offset:1024
    ds_read_b128 v[60:63], v155 offset:4096
    v_mfma_f32_32x32x16_bf16 v[128:143], v[44:47], v[68:71], v[128:143]
    s_waitcnt lgkmcnt(6)
    v_mfma_f32_32x32x16_bf16 v[80:95], v[48:51], v[72:75], v[80:95]
    s_barrier
    ds_read_b128 v[64:67], v152 offset:32768
    ds_read_b64_tr_b16 v[40:41], v156 offset:32768
    v_mfma_f32_32x32x16_bf16 v[96:111], v[52:55], v[72:75], v[96:111]
    ds_read_b64_tr_b16 v[42:43], v156 offset:33792
    ds_read_b64_tr_b16 v[44:45], v157 offset:32768
    v_mfma_f32_4x4x4_16b_bf16 v[144:147], v[16:17], v[48:49], v[144:147]
    v_mfma_f32_4x4x4_16b_bf16 v[148:151], v[16:17], v[52:53], v[148:151]
    v_mfma_f32_32x32x16_bf16 v[112:127], v[48:51], v[76:79], v[112:127]
    ds_read_b64_tr_b16 v[46:47], v157 offset:33792
    ds_read_b128 v[68:71], v152 offset:36864
    v_mfma_f32_32x32x16_bf16 v[128:143], v[52:55], v[76:79], v[128:143]
    v_mfma_f32_4x4x4_16b_bf16 v[144:147], v[16:17], v[50:51], v[144:147]
    v_mfma_f32_4x4x4_16b_bf16 v[148:151], v[16:17], v[54:55], v[148:151]
    s_waitcnt lgkmcnt(6)
    v_mfma_f32_32x32x16_bf16 v[80:95], v[32:35], v[56:59], v[80:95]
    ds_read_b128 v[72:75], v154 offset:32768
    ds_read_b64_tr_b16 v[48:49], v160 offset:32768
    v_mfma_f32_32x32x16_bf16 v[96:111], v[36:39], v[56:59], v[96:111]
    ds_read_b64_tr_b16 v[50:51], v160 offset:33792
    ds_read_b64_tr_b16 v[52:53], v161 offset:32768
    v_mfma_f32_32x32x16_bf16 v[112:127], v[32:35], v[60:63], v[112:127]
    ds_read_b64_tr_b16 v[54:55], v161 offset:33792
    ds_read_b128 v[76:79], v154 offset:36864
    v_mfma_f32_32x32x16_bf16 v[128:143], v[36:39], v[60:63], v[128:143]
    s_waitcnt lgkmcnt(6)
    v_mfma_f32_32x32x16_bf16 v[80:95], v[40:43], v[64:67], v[80:95]
    ds_read_b128 v[56:59], v153 offset:32768
    ds_read_b64_tr_b16 v[32:33], v158 offset:32768
    v_mfma_f32_32x32x16_bf16 v[96:111], v[44:47], v[64:67], v[96:111]
    ds_read_b64_tr_b16 v[34:35], v158 offset:33792
    ds_read_b64_tr_b16 v[36:37], v159 offset:32768
    v_mfma_f32_4x4x4_16b_bf16 v[144:147], v[16:17], v[40:41], v[144:147]
    v_mfma_f32_4x4x4_16b_bf16 v[148:151], v[16:17], v[44:45], v[148:151]
    v_mfma_f32_32x32x16_bf16 v[112:127], v[40:43], v[68:71], v[112:127]
    ds_read_b64_tr_b16 v[38:39], v159 offset:33792
    ds_read_b128 v[60:63], v153 offset:36864
    v_mfma_f32_32x32x16_bf16 v[128:143], v[44:47], v[68:71], v[128:143]
    v_mfma_f32_4x4x4_16b_bf16 v[144:147], v[16:17], v[42:43], v[144:147]
    v_mfma_f32_4x4x4_16b_bf16 v[148:151], v[16:17], v[46:47], v[148:151]
    s_waitcnt lgkmcnt(6)
    v_mfma_f32_32x32x16_bf16 v[80:95], v[48:51], v[72:75], v[80:95]
    ds_read_b128 v[64:67], v155 offset:32768
    ds_read_b64_tr_b16 v[40:41], v162 offset:32768
    v_mfma_f32_32x32x16_bf16 v[96:111], v[52:55], v[72:75], v[96:111]
    ds_read_b64_tr_b16 v[42:43], v162 offset:33792
    ds_read_b64_tr_b16 v[44:45], v163 offset:32768
    v_mfma_f32_4x4x4_16b_bf16 v[144:147], v[16:17], v[48:49], v[144:147]
    v_mfma_f32_4x4x4_16b_bf16 v[148:151], v[16:17], v[52:53], v[148:151]
    v_mfma_f32_32x32x16_bf16 v[112:127], v[48:51], v[76:79], v[112:127]
    ds_read_b64_tr_b16 v[46:47], v163 offset:33792
    ds_read_b128 v[68:71], v155 offset:36864
    v_mfma_f32_32x32x16_bf16 v[128:143], v[52:55], v[76:79], v[128:143]
    v_mfma_f32_4x4x4_16b_bf16 v[144:147], v[16:17], v[50:51], v[144:147]
    v_mfma_f32_4x4x4_16b_bf16 v[148:151], v[16:17], v[54:55], v[148:151]
    s_waitcnt lgkmcnt(6)
    v_mfma_f32_32x32x16_bf16 v[80:95], v[32:35], v[56:59], v[80:95]
    s_nop 2
    v_permlane32_swap_b32 v144, v148
    v_add_f32 v144, v144, v148
    ds_write_b32 v20, v144
    s_lshl_b32 s28, s20, 2
    s_add_u32 s28, s28, 157312
    v_mov_b32 v164, s28
    v_mov_b32 v165, 1
    ds_write_b32 v164, v165
    v_xor_b32 v164, 4, v164
    v_mfma_f32_32x32x16_bf16 v[96:111], v[36:39], v[56:59], v[96:111]
    v_mfma_f32_32x32x16_bf16 v[112:127], v[32:35], v[60:63], v[112:127]
    v_mfma_f32_32x32x16_bf16 v[128:143], v[36:39], v[60:63], v[128:143]
    s_waitcnt lgkmcnt(2)
    v_mfma_f32_32x32x16_bf16 v[80:95], v[40:43], v[64:67], v[80:95]
    v_mfma_f32_32x32x16_bf16 v[96:111], v[44:47], v[64:67], v[96:111]
    v_mfma_f32_32x32x16_bf16 v[112:127], v[40:43], v[68:71], v[112:127]
    v_mfma_f32_32x32x16_bf16 v[128:143], v[44:47], v[68:71], v[128:143]
L_c_cs:
    ds_read_b32 v165, v164 offset:0
    s_waitcnt lgkmcnt(0)
    v_readfirstlane_b32 s28, v165
    s_nop 0
    s_cmp_eq_u32 s28, 1
    s_cbranch_scc0 L_c_cs
    ds_read_b32 v166, v21
    s_waitcnt vmcnt(2)
    v_cmp_ne_u32 vcc, s76, v189
    s_nop 0
    s_cbranch_vccz L_g1_sok
    s_mov_b32 s30, 0
L_g1_spoll:
    buffer_load_dwordx2 v[188:189], v22, s[12:15], s36 offen sc1
    s_add_u32 s30, s30, 1
    s_waitcnt vmcnt(0)
    v_cmp_ne_u32 vcc, s76, v189
    s_cmp_gt_u32 s30, 262144
    s_cbranch_scc1 L_g1_sok
    s_cbranch_vccnz L_g1_spoll
L_g1_sok:
    v_mov_b32 v189, v188
    s_mov_b32 s28, -1
    s_mov_b32 s29, 0
    v_permlane32_swap_b32 v188, v189
    s_waitcnt lgkmcnt(0)
    v_add_f32 v166, v166, v144
    v_and_b32 v212, 0xffff0000, v188
    v_and_b32 v167, 0xffff0000, v166
    v_and_b32 v172, 0xffff, v188
    v_sub_f32 v167, v166, v167
    v_rcp_f32 v170, v212
    v_lshrrev_b32 v166, 16, v166
    v_lshl_or_b32 v172, v172, 16, v172
    v_and_b32 v168, 0xffff0000, v167
    v_cndmask_b32 v196, 0, v172, s[28:29]
    v_sub_f32 v169, v167, v168
    v_cndmask_b32 v197, 0, v188, s[28:29]
    v_or_b32 v192, v166, v168
    v_cndmask_b32 v200, v172, 0, s[28:29]
    v_lshrrev_b32 v169, 16, v169
    v_cndmask_b32 v201, v188, 0, s[28:29]
    v_or_b32 v193, v169, v19
    v_and_b32 v213, 0xffff0000, v189
    v_and_b32 v173, 0xffff, v189
    v_rcp_f32 v171, v213
    v_lshl_or_b32 v173, v173, 16, v173
    v_cndmask_b32 v204, 0, v173, s[28:29]
    v_cndmask_b32 v205, 0, v189, s[28:29]
    v_cndmask_b32 v208, v173, 0, s[28:29]
    v_cndmask_b32 v209, v189, 0, s[28:29]
    v_mfma_f32_32x32x16_bf16 v[80:95], v[192:195], v[196:199], v[80:95]
    v_fma_f32 v174, -v212, v170, 1.0
    v_fma_f32 v175, -v213, v171, 1.0
    v_fma_f32 v170, v174, v170, v170
    v_mfma_f32_32x32x16_bf16 v[96:111], v[192:195], v[200:203], v[96:111]
    v_fma_f32 v171, v175, v171, v171
    v_mul_f32 v214, 0xc0135761, v170
    v_mul_f32 v215, 0xc0135761, v171
    v_mfma_f32_32x32x16_bf16 v[112:127], v[192:195], v[204:207], v[112:127]
    v_mul_f32 v174, v170, v170
    v_mul_f32 v175, v171, v171
    v_mul_f32 v216, 0xbdd2d3e8, v170
    v_mfma_f32_32x32x16_bf16 v[128:143], v[192:195], v[208:211], v[128:143]
    v_mul_f32 v217, 0xbdd2d3e8, v171
    v_mul_f32 v216, v216, v174
    v_mul_f32 v217, v217, v175
    v_mov_b32 v220, v214
    v_mov_b32 v221, v214
    v_mov_b32 v222, v216
    v_mov_b32 v223, v216
    v_mov_b32 v224, v212
    v_mov_b32 v225, v212
    v_pk_mul_f32 v[164:165], v[80:81], v[80:81]
    v_pk_mul_f32 v[166:167], v[82:83], v[82:83]
    v_pk_mul_f32 v[168:169], v[84:85], v[84:85]
    v_pk_mul_f32 v[170:171], v[86:87], v[86:87]
    v_pk_fma_f32 v[164:165], v[164:165], v[222:223], v[220:221]
    v_pk_fma_f32 v[166:167], v[166:167], v[222:223], v[220:221]
    v_pk_fma_f32 v[168:169], v[168:169], v[222:223], v[220:221]
    v_pk_fma_f32 v[170:171], v[170:171], v[222:223], v[220:221]
    v_pk_mul_f32 v[164:165], v[164:165], v[80:81]
    v_pk_mul_f32 v[166:167], v[166:167], v[82:83]
    v_pk_mul_f32 v[168:169], v[168:169], v[84:85]
    v_pk_mul_f32 v[170:171], v[170:171], v[86:87]
    v_exp_f32 v164, v164
    v_exp_f32 v165, v165
    v_exp_f32 v166, v166
    v_exp_f32 v167, v167
    v_exp_f32 v168, v168
    v_exp_f32 v169, v169
    v_exp_f32 v170, v170
    v_exp_f32 v171, v171
    v_pk_fma_f32 v[164:165], v[164:165], v[224:225], v[224:225]
    v_pk_fma_f32 v[166:167], v[166:167], v[224:225], v[224:225]
    v_pk_fma_f32 v[168:169], v[168:169], v[224:225], v[224:225]
    v_pk_fma_f32 v[170:171], v[170:171], v[224:225], v[224:225]
    v_rcp_f32 v164, v164
    v_rcp_f32 v165, v165
    v_rcp_f32 v166, v166
    v_rcp_f32 v167, v167
    v_rcp_f32 v168, v168
    v_rcp_f32 v169, v169
    v_rcp_f32 v170, v170
    v_rcp_f32 v171, v171
    v_pk_mul_f32 v[80:81], v[80:81], v[164:165]
    v_pk_mul_f32 v[82:83], v[82:83], v[166:167]
    v_pk_mul_f32 v[84:85], v[84:85], v[168:169]
    v_pk_mul_f32 v[86:87], v[86:87], v[170:171]
    v_cvt_pk_bf16_f32 v180, v80, v81
    v_cvt_pk_bf16_f32 v181, v82, v83
    v_cvt_pk_bf16_f32 v182, v84, v85
    v_cvt_pk_bf16_f32 v183, v86, v87
    buffer_store_dwordx4 v[180:183], v18, s[12:15], s32 offen offset:0 sc1
    v_pk_mul_f32 v[172:173], v[88:89], v[88:89]
    v_pk_mul_f32 v[174:175], v[90:91], v[90:91]
    v_pk_mul_f32 v[176:177], v[92:93], v[92:93]
    v_pk_mul_f32 v[178:179], v[94:95], v[94:95]
    v_pk_fma_f32 v[172:173], v[172:173], v[222:223], v[220:221]
    v_pk_fma_f32 v[174:175], v[174:175], v[222:223], v[220:221]
    v_pk_fma_f32 v[176:177], v[176:177], v[222:223], v[220:221]
    v_pk_fma_f32 v[178:179], v[178:179], v[222:223], v[220:221]
    v_pk_mul_f32 v[172:173], v[172:173], v[88:89]
    v_pk_mul_f32 v[174:175], v[174:175], v[90:91]
    v_pk_mul_f32 v[176:177], v[176:177], v[92:93]
    v_pk_mul_f32 v[178:179], v[178:179], v[94:95]
    v_exp_f32 v172, v172
    v_exp_f32 v173, v173
    v_exp_f32 v174, v174
    v_exp_f32 v175, v175
    v_exp_f32 v176, v176
    v_exp_f32 v177, v177
    v_exp_f32 v178, v178
    v_exp_f32 v179, v179
    v_pk_fma_f32 v[172:173], v[172:173], v[224:225], v[224:225]
    v_pk_fma_f32 v[174:175], v[174:175], v[224:225], v[224:225]
    v_pk_fma_f32 v[176:177], v[176:177], v[224:225], v[224:225]
    v_pk_fma_f32 v[178:179], v[178:179], v[224:225], v[224:225]
    v_rcp_f32 v172, v172
    v_rcp_f32 v173, v173
    v_rcp_f32 v174, v174
    v_rcp_f32 v175, v175
    v_rcp_f32 v176, v176
    v_rcp_f32 v177, v177
    v_rcp_f32 v178, v178
    v_rcp_f32 v179, v179
    v_pk_mul_f32 v[88:89], v[88:89], v[172:173]
    v_pk_mul_f32 v[90:91], v[90:91], v[174:175]
    v_pk_mul_f32 v[92:93], v[92:93], v[176:177]
    v_pk_mul_f32 v[94:95], v[94:95], v[178:179]
    v_cvt_pk_bf16_f32 v184, v88, v89
    v_cvt_pk_bf16_f32 v185, v90, v91
    v_cvt_pk_bf16_f32 v186, v92, v93
    v_cvt_pk_bf16_f32 v187, v94, v95
    buffer_store_dwordx4 v[184:187], v18, s[12:15], s32 offen offset:1024 sc1
    v_pk_mul_f32 v[164:165], v[96:97], v[96:97]
    v_pk_mul_f32 v[166:167], v[98:99], v[98:99]
    v_pk_mul_f32 v[168:169], v[100:101], v[100:101]
    v_pk_mul_f32 v[170:171], v[102:103], v[102:103]
    v_pk_fma_f32 v[164:165], v[164:165], v[222:223], v[220:221]
    v_pk_fma_f32 v[166:167], v[166:167], v[222:223], v[220:221]
    v_pk_fma_f32 v[168:169], v[168:169], v[222:223], v[220:221]
    v_pk_fma_f32 v[170:171], v[170:171], v[222:223], v[220:221]
    v_pk_mul_f32 v[164:165], v[164:165], v[96:97]
    v_pk_mul_f32 v[166:167], v[166:167], v[98:99]
    v_pk_mul_f32 v[168:169], v[168:169], v[100:101]
    v_pk_mul_f32 v[170:171], v[170:171], v[102:103]
    v_exp_f32 v164, v164
    v_exp_f32 v165, v165
    v_exp_f32 v166, v166
    v_exp_f32 v167, v167
    v_exp_f32 v168, v168
    v_exp_f32 v169, v169
    v_exp_f32 v170, v170
    v_exp_f32 v171, v171
    v_pk_fma_f32 v[164:165], v[164:165], v[224:225], v[224:225]
    v_pk_fma_f32 v[166:167], v[166:167], v[224:225], v[224:225]
    v_pk_fma_f32 v[168:169], v[168:169], v[224:225], v[224:225]
    v_pk_fma_f32 v[170:171], v[170:171], v[224:225], v[224:225]
    v_rcp_f32 v164, v164
    v_rcp_f32 v165, v165
    v_rcp_f32 v166, v166
    v_rcp_f32 v167, v167
    v_rcp_f32 v168, v168
    v_rcp_f32 v169, v169
    v_rcp_f32 v170, v170
    v_rcp_f32 v171, v171
    v_pk_mul_f32 v[96:97], v[96:97], v[164:165]
    v_pk_mul_f32 v[98:99], v[98:99], v[166:167]
    v_pk_mul_f32 v[100:101], v[100:101], v[168:169]
    v_pk_mul_f32 v[102:103], v[102:103], v[170:171]
    v_cvt_pk_bf16_f32 v180, v96, v97
    v_cvt_pk_bf16_f32 v181, v98, v99
    v_cvt_pk_bf16_f32 v182, v100, v101
    v_cvt_pk_bf16_f32 v183, v102, v103
    buffer_store_dwordx4 v[180:183], v18, s[12:15], s32 offen offset:2048 sc1
    v_pk_mul_f32 v[172:173], v[104:105], v[104:105]
    v_pk_mul_f32 v[174:175], v[106:107], v[106:107]
    v_pk_mul_f32 v[176:177], v[108:109], v[108:109]
    v_pk_mul_f32 v[178:179], v[110:111], v[110:111]
    v_pk_fma_f32 v[172:173], v[172:173], v[222:223], v[220:221]
    v_pk_fma_f32 v[174:175], v[174:175], v[222:223], v[220:221]
    v_pk_fma_f32 v[176:177], v[176:177], v[222:223], v[220:221]
    v_pk_fma_f32 v[178:179], v[178:179], v[222:223], v[220:221]
    v_pk_mul_f32 v[172:173], v[172:173], v[104:105]
    v_pk_mul_f32 v[174:175], v[174:175], v[106:107]
    v_pk_mul_f32 v[176:177], v[176:177], v[108:109]
    v_pk_mul_f32 v[178:179], v[178:179], v[110:111]
    v_exp_f32 v172, v172
    v_exp_f32 v173, v173
    v_exp_f32 v174, v174
    v_exp_f32 v175, v175
    v_exp_f32 v176, v176
    v_exp_f32 v177, v177
    v_exp_f32 v178, v178
    v_exp_f32 v179, v179
    v_pk_fma_f32 v[172:173], v[172:173], v[224:225], v[224:225]
    v_pk_fma_f32 v[174:175], v[174:175], v[224:225], v[224:225]
    v_pk_fma_f32 v[176:177], v[176:177], v[224:225], v[224:225]
    v_pk_fma_f32 v[178:179], v[178:179], v[224:225], v[224:225]
    v_rcp_f32 v172, v172
    v_rcp_f32 v173, v173
    v_rcp_f32 v174, v174
    v_rcp_f32 v175, v175
    v_rcp_f32 v176, v176
    v_rcp_f32 v177, v177
    v_rcp_f32 v178, v178
    v_rcp_f32 v179, v179
    v_pk_mul_f32 v[104:105], v[104:105], v[172:173]
    v_pk_mul_f32 v[106:107], v[106:107], v[174:175]
    v_pk_mul_f32 v[108:109], v[108:109], v[176:177]
    v_pk_mul_f32 v[110:111], v[110:111], v[178:179]
    v_cvt_pk_bf16_f32 v184, v104, v105
    v_cvt_pk_bf16_f32 v185, v106, v107
    v_cvt_pk_bf16_f32 v186, v108, v109
    v_cvt_pk_bf16_f32 v187, v110, v111
    buffer_store_dwordx4 v[184:187], v18, s[12:15], s32 offen offset:3072 sc1
    v_mov_b32 v226, v215
    v_mov_b32 v227, v215
    v_mov_b32 v228, v217
    v_mov_b32 v229, v217
    v_mov_b32 v230, v213
    v_mov_b32 v231, v213
    v_pk_mul_f32 v[164:165], v[112:113], v[112:113]
    v_pk_mul_f32 v[166:167], v[114:115], v[114:115]
    v_pk_mul_f32 v[168:169], v[116:117], v[116:117]
    v_pk_mul_f32 v[170:171], v[118:119], v[118:119]
    v_pk_fma_f32 v[164:165], v[164:165], v[228:229], v[226:227]
    v_pk_fma_f32 v[166:167], v[166:167], v[228:229], v[226:227]
    v_pk_fma_f32 v[168:169], v[168:169], v[228:229], v[226:227]
    v_pk_fma_f32 v[170:171], v[170:171], v[228:229], v[226:227]
    v_pk_mul_f32 v[164:165], v[164:165], v[112:113]
    v_pk_mul_f32 v[166:167], v[166:167], v[114:115]
    v_pk_mul_f32 v[168:169], v[168:169], v[116:117]
    v_pk_mul_f32 v[170:171], v[170:171], v[118:119]
    v_exp_f32 v164, v164
    v_exp_f32 v165, v165
    v_exp_f32 v166, v166
    v_exp_f32 v167, v167
    v_exp_f32 v168, v168
    v_exp_f32 v169, v169
    v_exp_f32 v170, v170
    v_exp_f32 v171, v171
    v_pk_fma_f32 v[164:165], v[164:165], v[230:231], v[230:231]
    v_pk_fma_f32 v[166:167], v[166:167], v[230:231], v[230:231]
    v_pk_fma_f32 v[168:169], v[168:169], v[230:231], v[230:231]
    v_pk_fma_f32 v[170:171], v[170:171], v[230:231], v[230:231]
    v_rcp_f32 v164, v164
    v_rcp_f32 v165, v165
    v_rcp_f32 v166, v166
    v_rcp_f32 v167, v167
    v_rcp_f32 v168, v168
    v_rcp_f32 v169, v169
    v_rcp_f32 v170, v170
    v_rcp_f32 v171, v171
    v_pk_mul_f32 v[112:113], v[112:113], v[164:165]
    v_pk_mul_f32 v[114:115], v[114:115], v[166:167]
    v_pk_mul_f32 v[116:117], v[116:117], v[168:169]
    v_pk_mul_f32 v[118:119], v[118:119], v[170:171]
    v_cvt_pk_bf16_f32 v180, v112, v113
    v_cvt_pk_bf16_f32 v181, v114, v115
    v_cvt_pk_bf16_f32 v182, v116, v117
    v_cvt_pk_bf16_f32 v183, v118, v119
    buffer_store_dwordx4 v[180:183], v18, s[12:15], s38 offen offset:0 sc1
    v_pk_mul_f32 v[172:173], v[120:121], v[120:121]
    v_pk_mul_f32 v[174:175], v[122:123], v[122:123]
    v_pk_mul_f32 v[176:177], v[124:125], v[124:125]
    v_pk_mul_f32 v[178:179], v[126:127], v[126:127]
    v_pk_fma_f32 v[172:173], v[172:173], v[228:229], v[226:227]
    v_pk_fma_f32 v[174:175], v[174:175], v[228:229], v[226:227]
    v_pk_fma_f32 v[176:177], v[176:177], v[228:229], v[226:227]
    v_pk_fma_f32 v[178:179], v[178:179], v[228:229], v[226:227]
    v_pk_mul_f32 v[172:173], v[172:173], v[120:121]
    v_pk_mul_f32 v[174:175], v[174:175], v[122:123]
    v_pk_mul_f32 v[176:177], v[176:177], v[124:125]
    v_pk_mul_f32 v[178:179], v[178:179], v[126:127]
    v_exp_f32 v172, v172
    v_exp_f32 v173, v173
    v_exp_f32 v174, v174
    v_exp_f32 v175, v175
    v_exp_f32 v176, v176
    v_exp_f32 v177, v177
    v_exp_f32 v178, v178
    v_exp_f32 v179, v179
    v_pk_fma_f32 v[172:173], v[172:173], v[230:231], v[230:231]
    v_pk_fma_f32 v[174:175], v[174:175], v[230:231], v[230:231]
    v_pk_fma_f32 v[176:177], v[176:177], v[230:231], v[230:231]
    v_pk_fma_f32 v[178:179], v[178:179], v[230:231], v[230:231]
    v_rcp_f32 v172, v172
    v_rcp_f32 v173, v173
    v_rcp_f32 v174, v174
    v_rcp_f32 v175, v175
    v_rcp_f32 v176, v176
    v_rcp_f32 v177, v177
    v_rcp_f32 v178, v178
    v_rcp_f32 v179, v179
    v_pk_mul_f32 v[120:121], v[120:121], v[172:173]
    v_pk_mul_f32 v[122:123], v[122:123], v[174:175]
    v_pk_mul_f32 v[124:125], v[124:125], v[176:177]
    v_pk_mul_f32 v[126:127], v[126:127], v[178:179]
    v_cvt_pk_bf16_f32 v184, v120, v121
    v_cvt_pk_bf16_f32 v185, v122, v123
    v_cvt_pk_bf16_f32 v186, v124, v125
    v_cvt_pk_bf16_f32 v187, v126, v127
    buffer_store_dwordx4 v[184:187], v18, s[12:15], s38 offen offset:1024 sc1
    v_pk_mul_f32 v[164:165], v[128:129], v[128:129]
    v_pk_mul_f32 v[166:167], v[130:131], v[130:131]
    v_pk_mul_f32 v[168:169], v[132:133], v[132:133]
    v_pk_mul_f32 v[170:171], v[134:135], v[134:135]
    v_pk_fma_f32 v[164:165], v[164:165], v[228:229], v[226:227]
    v_pk_fma_f32 v[166:167], v[166:167], v[228:229], v[226:227]
    v_pk_fma_f32 v[168:169], v[168:169], v[228:229], v[226:227]
    v_pk_fma_f32 v[170:171], v[170:171], v[228:229], v[226:227]
    v_pk_mul_f32 v[164:165], v[164:165], v[128:129]
    v_pk_mul_f32 v[166:167], v[166:167], v[130:131]
    v_pk_mul_f32 v[168:169], v[168:169], v[132:133]
    v_pk_mul_f32 v[170:171], v[170:171], v[134:135]
    v_exp_f32 v164, v164
    v_exp_f32 v165, v165
    v_exp_f32 v166, v166
    v_exp_f32 v167, v167
    v_exp_f32 v168, v168
    v_exp_f32 v169, v169
    v_exp_f32 v170, v170
    v_exp_f32 v171, v171
    v_pk_fma_f32 v[164:165], v[164:165], v[230:231], v[230:231]
    v_pk_fma_f32 v[166:167], v[166:167], v[230:231], v[230:231]
    v_pk_fma_f32 v[168:169], v[168:169], v[230:231], v[230:231]
    v_pk_fma_f32 v[170:171], v[170:171], v[230:231], v[230:231]
    v_rcp_f32 v164, v164
    v_rcp_f32 v165, v165
    v_rcp_f32 v166, v166
    v_rcp_f32 v167, v167
    v_rcp_f32 v168, v168
    v_rcp_f32 v169, v169
    v_rcp_f32 v170, v170
    v_rcp_f32 v171, v171
    v_pk_mul_f32 v[128:129], v[128:129], v[164:165]
    v_pk_mul_f32 v[130:131], v[130:131], v[166:167]
    v_pk_mul_f32 v[132:133], v[132:133], v[168:169]
    v_pk_mul_f32 v[134:135], v[134:135], v[170:171]
    v_cvt_pk_bf16_f32 v180, v128, v129
    v_cvt_pk_bf16_f32 v181, v130, v131
    v_cvt_pk_bf16_f32 v182, v132, v133
    v_cvt_pk_bf16_f32 v183, v134, v135
    buffer_store_dwordx4 v[180:183], v18, s[12:15], s38 offen offset:2048 sc1
    v_pk_mul_f32 v[172:173], v[136:137], v[136:137]
    v_pk_mul_f32 v[174:175], v[138:139], v[138:139]
    v_pk_mul_f32 v[176:177], v[140:141], v[140:141]
    v_pk_mul_f32 v[178:179], v[142:143], v[142:143]
    v_pk_fma_f32 v[172:173], v[172:173], v[228:229], v[226:227]
    v_pk_fma_f32 v[174:175], v[174:175], v[228:229], v[226:227]
    v_pk_fma_f32 v[176:177], v[176:177], v[228:229], v[226:227]
    v_pk_fma_f32 v[178:179], v[178:179], v[228:229], v[226:227]
    v_pk_mul_f32 v[172:173], v[172:173], v[136:137]
    v_pk_mul_f32 v[174:175], v[174:175], v[138:139]
    v_pk_mul_f32 v[176:177], v[176:177], v[140:141]
    v_pk_mul_f32 v[178:179], v[178:179], v[142:143]
    v_exp_f32 v172, v172
    v_exp_f32 v173, v173
    v_exp_f32 v174, v174
    v_exp_f32 v175, v175
    v_exp_f32 v176, v176
    v_exp_f32 v177, v177
    v_exp_f32 v178, v178
    v_exp_f32 v179, v179
    v_pk_fma_f32 v[172:173], v[172:173], v[230:231], v[230:231]
    v_pk_fma_f32 v[174:175], v[174:175], v[230:231], v[230:231]
    v_pk_fma_f32 v[176:177], v[176:177], v[230:231], v[230:231]
    v_pk_fma_f32 v[178:179], v[178:179], v[230:231], v[230:231]
    v_rcp_f32 v172, v172
    v_rcp_f32 v173, v173
    v_rcp_f32 v174, v174
    v_rcp_f32 v175, v175
    v_rcp_f32 v176, v176
    v_rcp_f32 v177, v177
    v_rcp_f32 v178, v178
    v_rcp_f32 v179, v179
    v_pk_mul_f32 v[136:137], v[136:137], v[172:173]
    v_pk_mul_f32 v[138:139], v[138:139], v[174:175]
    v_pk_mul_f32 v[140:141], v[140:141], v[176:177]
    v_pk_mul_f32 v[142:143], v[142:143], v[178:179]
    v_cvt_pk_bf16_f32 v184, v136, v137
    v_cvt_pk_bf16_f32 v185, v138, v139
    v_cvt_pk_bf16_f32 v186, v140, v141
    v_cvt_pk_bf16_f32 v187, v142, v143
    buffer_store_dwordx4 v[184:187], v18, s[12:15], s38 offen offset:3072 sc1
    s_mov_b32 s37, 0
    s_branch L_gemm2
L_g1_H:
    s_nop 0
    s_add_u32 s42, s42, 0
    s_addc_u32 s43, s43, 0
    s_load_dword s76, s[42:43], 49152
    s_mov_b32 s4, s40
    s_mov_b32 s5, s41
    s_mov_b32 s6, 2097152
    s_mov_b32 s7, 0x00020000
    s_mov_b32 s8, s44
    s_mov_b32 s9, s45
    s_mov_b32 s10, 1835008
    s_mov_b32 s11, 0x00020000
    s_mov_b32 s12, s42
    s_mov_b32 s13, s43
    s_mov_b32 s14, 14680064
    s_mov_b32 s15, 0x00020000
    v_lshrrev_b32 v28, 3, v0
    v_and_b32 v29, 7, v0
    v_lshrrev_b32 v30, 4, v0
    v_xor_b32 v31, v30, v29
    v_lshlrev_b32 v1, 10, v28
    v_lshl_add_u32 v1, v31, 4, v1
    v_xor_b32 v3, 64, v1
    v_add_u32 v3, 8192, v3
    v_and_b32 v31, 15, v0
    v_lshlrev_b32 v28, 2, v30
    v_xor_b32 v31, v31, v28
    v_mul_u32_u24 v2, 3584, v30
    v_lshl_add_u32 v2, v31, 4, v2
    s_lshl_b32 s25, s21, 17
    s_lshl_b32 s28, s39, 15
    s_add_u32 s25, s25, s28
    s_mul_i32 s26, s39, 57344
    s_lshl_b32 s28, s22, 8
    s_add_u32 s26, s26, s28
    s_lshl_b32 s27, s39, 12
    s_mov_b32 s16, s48
    s_mov_b32 s17, s49
    s_mov_b32 s18, 1835008
    s_mov_b32 s19, 0x00020000
    v_lshrrev_b32 v28, 2, v0
    v_and_b32 v28, 4, v28
    v_and_b32 v29, 7, v0
    v_xor_b32 v28, v28, v29
    v_lshrrev_b32 v29, 3, v0
    v_lshlrev_b32 v23, 10, v29
    v_lshl_add_u32 v23, v28, 4, v23
    s_mul_i32 s72, s39, 458752
    s_lshl_b32 s75, s79, 7
    s_add_u32 s72, s72, s75
    s_lshl_b32 s73, s39, 13
    v_lshrrev_b32 v29, 5, v0
    v_bfe_u32 v28, v0, 2, 2
    v_lshl_add_u32 v24, v29, 2, v28
    v_lshlrev_b32 v24, 7, v24
    v_bfe_u32 v28, v0, 4, 1
    v_lshl_add_u32 v24, v28, 5, v24
    v_and_b32 v28, 3, v0
    v_lshl_add_u32 v24, v28, 3, v24
    v_bfe_u32 v28, v0, 3, 1
    v_lshl_add_u32 v24, v28, 6, v24
    v_add_u32 v24, s73, v24
    v_xor_b32 v25, 64, v24
    v_add_u32 v26, 0x10000, v24
    v_add_u32 v27, 0x10000, v25
    s_lshl_b32 s28, s39, 13
    s_add_u32 s28, s28, 98304
    v_lshl_add_u32 v100, v0, 2, s28
    v_xor_b32 v101, 16, v100
    v_xor_b32 v102, 32, v100
    v_xor_b32 v103, 48, v100
    v_xor_b32 v104, 64, v100
    v_xor_b32 v105, 80, v100
    v_xor_b32 v106, 96, v100
    v_xor_b32 v107, 112, v100
    v_xor_b32 v108, 128, v100
    v_xor_b32 v109, 144, v100
    v_xor_b32 v110, 160, v100
    v_xor_b32 v111, 176, v100
    v_xor_b32 v112, 192, v100
    v_xor_b32 v113, 208, v100
    v_xor_b32 v114, 224, v100
    v_xor_b32 v115, 240, v100
    s_lshl_b32 s28, s39, 13
    s_add_u32 s28, s28, 98304
    v_and_b32 v28, 15, v0
    v_lshrrev_b32 v29, 5, v0
    v_xor_b32 v28, v28, v29
    v_and_b32 v29, 31, v0
    v_lshlrev_b32 v29, 8, v29
    v_lshl_add_u32 v116, v28, 4, v29
    v_add_u32 v116, s28, v116
    v_xor_b32 v117, 32, v116
    v_xor_b32 v118, 64, v116
    v_xor_b32 v119, 96, v116
    v_xor_b32 v120, 128, v116
    v_xor_b32 v121, 160, v116
    v_xor_b32 v122, 192, v116
    v_xor_b32 v123, 224, v116
    v_lshlrev_b32 v28, 2, v0
    v_mov_b32 v29, 0
    v_add_u32 v28, 157184, v28
    ds_write_b32 v28, v29
    s_barrier
    s_lshr_b32 s30, s39, 1
    s_mul_i32 s30, s30, 13056
    s_add_u32 s38, s30, 131072
    s_lshl_b32 s30, s39, 13
    s_add_u32 s30, s30, 98304
    v_lshl_add_u32 v146, v0, 4, s30
    v_xor_b32 v147, 8192, v146
    v_and_b32 v28, 31, v0
    v_lshrrev_b32 v29, 5, v0
    v_lshlrev_b32 v30, 4, v28
    s_add_u32 s28, s38, 7664
    v_sub_u32 v254, s28, v30
    v_lshlrev_b32 v31, 9, v29
    v_sub_u32 v254, v254, v31
    s_add_u32 s28, s38, 6128
    v_sub_u32 v255, s28, v30
    v_lshlrev_b32 v31, 10, v29
    v_sub_u32 v255, v255, v31
    v_lshl_add_u32 v148, v0, 3, s38
    v_mov_b32 v150, 0
    v_mov_b32 v151, 0
    v_mov_b32 v152, 1
    s_lshl_b32 s28, s39, 2
    s_add_u32 s28, s28, 157184
    v_mov_b32 v149, s28
    v_xor_b32 v153, 4, v149
    s_lshl_b32 s29, s79, 6
    s_lshl_b32 s28, s39, 4
    s_add_u32 s29, s29, s28
    s_lshr_b32 s28, s78, 4
    s_lshl_b32 s28, s28, 9
    s_add_u32 s29, s29, s28
    s_lshl_b32 s29, s29, 2
    s_add_u32 s29, s29, 262144
    v_lshlrev_b32 v154, 2, v0
    v_add_u32 v154, 32768, v154
    v_and_b32 v155, 15, v0
    v_lshl_add_u32 v155, v155, 2, s29
    s_mov_b32 s28, 0
    s_mov_b32 s29, -1
    v_cndmask_b32 v154, v154, v155, s[28:29]
    s_bitcmp0_b32 s39, 0
    s_cselect_b64 s[28:29], -1, 0
    s_mov_b64 exec, s[28:29]
    ds_write_b64 v148, v[150:151]
    s_and_b64 exec, s[28:29], 15
    ds_write_b64 v148, v[150:151] offset:8704
    ds_write_b64 v148, v[150:151] offset:12864
    s_mov_b64 exec, -1
    s_waitcnt vmcnt(1)
L_kgen_v:
    v_mul_f32 v34, 0x3fb8aa00, v250
    v_mul_f32 v35, 0x36a407db, v250
    v_exp_f32 v34, v34
    s_nop 0
    v_fma_f32 v34, v34, v35, v34
    v_cvt_pk_bf16_f32 v34, v34, v34
    v_and_b32 v34, 0xffff0000, v34
    v_mul_f32 v144, v34, v244
    v_mul_f32 v145, v34, v245
    v_mul_f32 v246, v34, v246
    v_mul_f32 v247, v34, v247
    v_mul_f32 v144, 0x3fb8aa3b, v144
    v_mul_f32 v145, 0.15915494, v145
    v_mul_f32 v34, 0x41000000, v144
    v_mul_f32 v35, 0x41000000, v145
    v_exp_f32 v34, v34
    v_fract_f32 v35, v35
    v_cos_f32 v44, v35
    v_sin_f32 v45, v35
    v_mul_f32 v44, v44, v34
    v_mul_f32 v45, v45, v34
    v_pk_mul_f32 v[46:47], v[44:45], v[44:45] op_sel:[0,0] op_sel_hi:[0,1]
    v_pk_fma_f32 v[46:47], v[44:45], v[44:45], v[46:47] op_sel:[1,1,0] op_sel_hi:[1,0,1] neg_lo:[0,1,0]
    v_mov_b32 v95, 0x00003f80
    ds_write_b32 v100, v95
    v_cvt_pk_bf16_f32 v88, v44, v45
    ds_write_b32 v101, v88 offset:256
    v_cvt_pk_bf16_f32 v89, v46, v47
    ds_write_b32 v102, v89 offset:512
    v_pk_mul_f32 v[80:81], v[44:45], v[46:47] op_sel:[0,0] op_sel_hi:[0,1]
    v_pk_mul_f32 v[84:85], v[46:47], v[46:47] op_sel:[0,0] op_sel_hi:[0,1]
    v_pk_fma_f32 v[80:81], v[44:45], v[46:47], v[80:81] op_sel:[1,1,0] op_sel_hi:[1,0,1] neg_lo:[0,1,0]
    v_pk_fma_f32 v[84:85], v[46:47], v[46:47], v[84:85] op_sel:[1,1,0] op_sel_hi:[1,0,1] neg_lo:[0,1,0]
    v_cvt_pk_bf16_f32 v90, v80, v81
    v_cvt_pk_bf16_f32 v91, v84, v85
    ds_write_b32 v103, v90 offset:768
    ds_write_b32 v104, v91 offset:1024
    v_pk_mul_f32 v[82:83], v[80:81], v[46:47] op_sel:[0,0] op_sel_hi:[0,1]
    v_pk_mul_f32 v[86:87], v[84:85], v[46:47] op_sel:[0,0] op_sel_hi:[0,1]
    v_pk_fma_f32 v[82:83], v[80:81], v[46:47], v[82:83] op_sel:[1,1,0] op_sel_hi:[1,0,1] neg_lo:[0,1,0]
    v_pk_fma_f32 v[86:87], v[84:85], v[46:47], v[86:87] op_sel:[1,1,0] op_sel_hi:[1,0,1] neg_lo:[0,1,0]
    v_cvt_pk_bf16_f32 v92, v82, v83
    v_cvt_pk_bf16_f32 v93, v86, v87
    ds_write_b32 v105, v92 offset:1280
    ds_write_b32 v106, v93 offset:1536
    v_pk_mul_f32 v[80:81], v[82:83], v[46:47] op_sel:[0,0] op_sel_hi:[0,1]
    v_pk_mul_f32 v[84:85], v[86:87], v[46:47] op_sel:[0,0] op_sel_hi:[0,1]
    v_pk_fma_f32 v[80:81], v[82:83], v[46:47], v[80:81] op_sel:[1,1,0] op_sel_hi:[1,0,1] neg_lo:[0,1,0]
    v_pk_fma_f32 v[84:85], v[86:87], v[46:47], v[84:85] op_sel:[1,1,0] op_sel_hi:[1,0,1] neg_lo:[0,1,0]
    v_cvt_pk_bf16_f32 v94, v80, v81
    v_cvt_pk_bf16_f32 v95, v84, v85
    ds_write_b32 v107, v94 offset:1792
    ds_write_b32 v108, v95 offset:2048
    v_pk_mul_f32 v[82:83], v[80:81], v[46:47] op_sel:[0,0] op_sel_hi:[0,1]
    v_pk_mul_f32 v[86:87], v[84:85], v[46:47] op_sel:[0,0] op_sel_hi:[0,1]
    v_pk_fma_f32 v[82:83], v[80:81], v[46:47], v[82:83] op_sel:[1,1,0] op_sel_hi:[1,0,1] neg_lo:[0,1,0]
    v_pk_fma_f32 v[86:87], v[84:85], v[46:47], v[86:87] op_sel:[1,1,0] op_sel_hi:[1,0,1] neg_lo:[0,1,0]
    v_cvt_pk_bf16_f32 v88, v82, v83
    v_cvt_pk_bf16_f32 v89, v86, v87
    ds_write_b32 v109, v88 offset:2304
    ds_write_b32 v110, v89 offset:2560
    v_pk_mul_f32 v[80:81], v[82:83], v[46:47] op_sel:[0,0] op_sel_hi:[0,1]
    v_pk_mul_f32 v[84:85], v[86:87], v[46:47] op_sel:[0,0] op_sel_hi:[0,1]
    v_pk_fma_f32 v[80:81], v[82:83], v[46:47], v[80:81] op_sel:[1,1,0] op_sel_hi:[1,0,1] neg_lo:[0,1,0]
    v_pk_fma_f32 v[84:85], v[86:87], v[46:47], v[84:85] op_sel:[1,1,0] op_sel_hi:[1,0,1] neg_lo:[0,1,0]
    v_cvt_pk_bf16_f32 v90, v80, v81
    v_cvt_pk_bf16_f32 v91, v84, v85
    ds_write_b32 v111, v90 offset:2816
    ds_write_b32 v112, v91 offset:3072
    v_pk_mul_f32 v[82:83], v[80:81], v[46:47] op_sel:[0,0] op_sel_hi:[0,1]
    v_pk_mul_f32 v[86:87], v[84:85], v[46:47] op_sel:[0,0] op_sel_hi:[0,1]
    v_pk_fma_f32 v[82:83], v[80:81], v[46:47], v[82:83] op_sel:[1,1,0] op_sel_hi:[1,0,1] neg_lo:[0,1,0]
    v_pk_fma_f32 v[86:87], v[84:85], v[46:47], v[86:87] op_sel:[1,1,0] op_sel_hi:[1,0,1] neg_lo:[0,1,0]
    v_cvt_pk_bf16_f32 v92, v82, v83
    v_cvt_pk_bf16_f32 v93, v86, v87
    ds_write_b32 v113, v92 offset:3328
    ds_write_b32 v114, v93 offset:3584
    v_pk_mul_f32 v[80:81], v[82:83], v[46:47] op_sel:[0,0] op_sel_hi:[0,1]
    v_pk_mul_f32 v[84:85], v[86:87], v[46:47] op_sel:[0,0] op_sel_hi:[0,1]
    v_pk_fma_f32 v[80:81], v[82:83], v[46:47], v[80:81] op_sel:[1,1,0] op_sel_hi:[1,0,1] neg_lo:[0,1,0]
    v_pk_fma_f32 v[84:85], v[86:87], v[46:47], v[84:85] op_sel:[1,1,0] op_sel_hi:[1,0,1] neg_lo:[0,1,0]
    v_cvt_pk_bf16_f32 v94, v80, v81
    v_cvt_pk_bf16_f32 v95, v84, v85
    ds_write_b32 v115, v94 offset:3840
    ds_write_b32 v100, v95 offset:4096
    v_pk_mul_f32 v[82:83], v[80:81], v[46:47] op_sel:[0,0] op_sel_hi:[0,1]
    v_pk_mul_f32 v[86:87], v[84:85], v[46:47] op_sel:[0,0] op_sel_hi:[0,1]
    v_pk_fma_f32 v[82:83], v[80:81], v[46:47], v[82:83] op_sel:[1,1,0] op_sel_hi:[1,0,1] neg_lo:[0,1,0]
    v_pk_fma_f32 v[86:87], v[84:85], v[46:47], v[86:87] op_sel:[1,1,0] op_sel_hi:[1,0,1] neg_lo:[0,1,0]
    v_cvt_pk_bf16_f32 v88, v82, v83
    v_cvt_pk_bf16_f32 v89, v86, v87
    ds_write_b32 v101, v88 offset:4352
    ds_write_b32 v102, v89 offset:4608
    v_pk_mul_f32 v[80:81], v[82:83], v[46:47] op_sel:[0,0] op_sel_hi:[0,1]
    v_pk_mul_f32 v[84:85], v[86:87], v[46:47] op_sel:[0,0] op_sel_hi:[0,1]
    v_pk_fma_f32 v[80:81], v[82:83], v[46:47], v[80:81] op_sel:[1,1,0] op_sel_hi:[1,0,1] neg_lo:[0,1,0]
    v_pk_fma_f32 v[84:85], v[86:87], v[46:47], v[84:85] op_sel:[1,1,0] op_sel_hi:[1,0,1] neg_lo:[0,1,0]
    v_cvt_pk_bf16_f32 v90, v80, v81
    v_cvt_pk_bf16_f32 v91, v84, v85
    ds_write_b32 v103, v90 offset:4864
    ds_write_b32 v104, v91 offset:5120
    v_pk_mul_f32 v[82:83], v[80:81], v[46:47] op_sel:[0,0] op_sel_hi:[0,1]
    v_pk_mul_f32 v[86:87], v[84:85], v[46:47] op_sel:[0,0] op_sel_hi:[0,1]
    v_pk_fma_f32 v[82:83], v[80:81], v[46:47], v[82:83] op_sel:[1,1,0] op_sel_hi:[1,0,1] neg_lo:[0,1,0]
    v_pk_fma_f32 v[86:87], v[84:85], v[46:47], v[86:87] op_sel:[1,1,0] op_sel_hi:[1,0,1] neg_lo:[0,1,0]
    v_cvt_pk_bf16_f32 v92, v82, v83
    v_cvt_pk_bf16_f32 v93, v86, v87
    ds_write_b32 v105, v92 offset:5376
    ds_write_b32 v106, v93 offset:5632
    v_pk_mul_f32 v[80:81], v[82:83], v[46:47] op_sel:[0,0] op_sel_hi:[0,1]
    v_pk_mul_f32 v[84:85], v[86:87], v[46:47] op_sel:[0,0] op_sel_hi:[0,1]
    v_pk_fma_f32 v[80:81], v[82:83], v[46:47], v[80:81] op_sel:[1,1,0] op_sel_hi:[1,0,1] neg_lo:[0,1,0]
    v_pk_fma_f32 v[84:85], v[86:87], v[46:47], v[84:85] op_sel:[1,1,0] op_sel_hi:[1,0,1] neg_lo:[0,1,0]
    v_cvt_pk_bf16_f32 v94, v80, v81
    v_cvt_pk_bf16_f32 v95, v84, v85
    ds_write_b32 v107, v94 offset:5888
    ds_write_b32 v108, v95 offset:6144
    v_pk_mul_f32 v[82:83], v[80:81], v[46:47] op_sel:[0,0] op_sel_hi:[0,1]
    v_pk_mul_f32 v[86:87], v[84:85], v[46:47] op_sel:[0,0] op_sel_hi:[0,1]
    v_pk_fma_f32 v[82:83], v[80:81], v[46:47], v[82:83] op_sel:[1,1,0] op_sel_hi:[1,0,1] neg_lo:[0,1,0]
    v_pk_fma_f32 v[86:87], v[84:85], v[46:47], v[86:87] op_sel:[1,1,0] op_sel_hi:[1,0,1] neg_lo:[0,1,0]
    v_cvt_pk_bf16_f32 v88, v82, v83
    v_cvt_pk_bf16_f32 v89, v86, v87
    ds_write_b32 v109, v88 offset:6400
    ds_write_b32 v110, v89 offset:6656
    v_pk_mul_f32 v[80:81], v[82:83], v[46:47] op_sel:[0,0] op_sel_hi:[0,1]
    v_pk_mul_f32 v[84:85], v[86:87], v[46:47] op_sel:[0,0] op_sel_hi:[0,1]
    v_pk_fma_f32 v[80:81], v[82:83], v[46:47], v[80:81] op_sel:[1,1,0] op_sel_hi:[1,0,1] neg_lo:[0,1,0]
    v_pk_fma_f32 v[84:85], v[86:87], v[46:47], v[84:85] op_sel:[1,1,0] op_sel_hi:[1,0,1] neg_lo:[0,1,0]
    v_cvt_pk_bf16_f32 v90, v80, v81
    v_cvt_pk_bf16_f32 v91, v84, v85
    ds_write_b32 v111, v90 offset:6912
    ds_write_b32 v112, v91 offset:7168
    v_pk_mul_f32 v[82:83], v[80:81], v[46:47] op_sel:[0,0] op_sel_hi:[0,1]
    v_pk_mul_f32 v[86:87], v[84:85], v[46:47] op_sel:[0,0] op_sel_hi:[0,1]
    v_pk_fma_f32 v[82:83], v[80:81], v[46:47], v[82:83] op_sel:[1,1,0] op_sel_hi:[1,0,1] neg_lo:[0,1,0]
    v_pk_fma_f32 v[86:87], v[84:85], v[46:47], v[86:87] op_sel:[1,1,0] op_sel_hi:[1,0,1] neg_lo:[0,1,0]
    v_cvt_pk_bf16_f32 v92, v82, v83
    v_cvt_pk_bf16_f32 v93, v86, v87
    ds_write_b32 v113, v92 offset:7424
    ds_write_b32 v114, v93 offset:7680
    v_pk_mul_f32 v[80:81], v[82:83], v[46:47] op_sel:[0,0] op_sel_hi:[0,1]
    v_pk_fma_f32 v[80:81], v[82:83], v[46:47], v[80:81] op_sel:[1,1,0] op_sel_hi:[1,0,1] neg_lo:[0,1,0]
    v_cvt_pk_bf16_f32 v94, v80, v81
    ds_write_b32 v115, v94 offset:7936
    ds_read_b128 v[160:163], v116
    ds_read_b128 v[164:167], v117
    ds_read_b128 v[168:171], v118
    ds_read_b128 v[172:175], v119
    ds_read_b128 v[176:179], v120
    ds_read_b128 v[180:183], v121
    ds_read_b128 v[184:187], v122
    ds_read_b128 v[188:191], v123
    s_cmp_eq_u32 s77, 7
    s_cbranch_scc1 L_ln_H2
    s_waitcnt lgkmcnt(0)
    s_barrier
    s_mul_i32 s76, s76, 0x9E3779B1
    s_add_u32 s76, s76, 0x7F4A7C15
    v_exp_f32 v36, v144
    v_mul_f32 v38, 0x43800000, v144
    v_mul_f32 v58, v248, v246
    v_fract_f32 v37, v145
    v_mul_f32 v39, 0x43800000, v145
    v_mul_f32 v59, v248, v247
    v_cos_f32 v42, v37
    v_exp_f32 v38, v38
    v_fma_f32 v58, -v249, v247, v58
    v_sin_f32 v43, v37
    v_fract_f32 v39, v39
    v_fma_f32 v59, v249, v246, v59
    v_mul_f32 v42, v42, v36
    v_cos_f32 v44, v39
    v_mul_f32 v43, v43, v36
    v_sin_f32 v45, v39
    v_mul_f32 v44, v44, v38
    v_mul_f32 v45, v45, v38
    v_cvt_pk_bf16_f32 v192, v58, -v59
    v_mul_f32 v46, v44, v44
    s_barrier
    s_add_u32 m0, s27, 98304
    s_add_u32 s31, s25, 384
    buffer_load_dwordx4 v1, s[4:7], s31 offen lds
    v_mul_f32 v60, v58, v42
    v_mul_f32 v47, v44, v45
    v_mul_f32 v61, v58, v43
    v_fma_f32 v46, -v45, v45, v46
    s_add_u32 m0, s27, 114688
    s_add_u32 s37, s26, 688128
    buffer_load_dwordx4 v2, s[8:11], s37 offen lds
    v_fma_f32 v60, -v59, v43, v60
    v_fma_f32 v47, v45, v44, v47
    v_fma_f32 v61, v59, v42, v61
    v_mul_f32 v48, v46, v44
    s_add_u32 m0, s27, 99328
    s_add_u32 s31, s25, 384
    buffer_load_dwordx4 v3, s[4:7], s31 offen lds
    v_cvt_pk_bf16_f32 v193, v60, -v61
    v_mul_f32 v49, v46, v45
    v_mul_f32 v62, v60, v42
    v_fma_f32 v48, -v47, v45, v48
    s_add_u32 m0, s27, 115712
    s_add_u32 s37, s26, 702464
    buffer_load_dwordx4 v2, s[8:11], s37 offen lds
    v_mul_f32 v63, v60, v43
    v_fma_f32 v49, v47, v44, v49
    v_fma_f32 v62, -v61, v43, v62
    v_mul_f32 v50, v48, v44
    s_add_u32 m0, s27, 100352
    s_add_u32 s31, s25, 16768
    buffer_load_dwordx4 v1, s[4:7], s31 offen lds
    v_fma_f32 v63, v61, v42, v63
    v_mul_f32 v51, v48, v45
    v_cvt_pk_bf16_f32 v194, v62, -v63
    v_fma_f32 v50, -v49, v45, v50
    s_add_u32 m0, s27, 116736
    s_add_u32 s37, s26, 716800
    buffer_load_dwordx4 v2, s[8:11], s37 offen lds
    v_mul_f32 v64, v62, v42
    v_fma_f32 v51, v49, v44, v51
    v_mul_f32 v65, v62, v43
    v_mul_f32 v52, v50, v44
    s_add_u32 m0, s27, 101376
    s_add_u32 s31, s25, 16768
    buffer_load_dwordx4 v3, s[4:7], s31 offen lds
    v_fma_f32 v64, -v63, v43, v64
    v_mul_f32 v53, v50, v45
    v_fma_f32 v65, v63, v42, v65
    v_fma_f32 v52, -v51, v45, v52
    s_add_u32 m0, s27, 117760
    s_add_u32 s37, s26, 731136
    buffer_load_dwordx4 v2, s[8:11], s37 offen lds
    v_cvt_pk_bf16_f32 v195, v64, -v65
    v_fma_f32 v53, v51, v44, v53
    v_mul_f32 v66, v64, v42
    v_mul_f32 v54, v52, v44
    s_barrier
    s_add_u32 m0, s27, 0
    s_add_u32 s31, s25, 512
    buffer_load_dwordx4 v1, s[4:7], s31 offen lds
    v_mul_f32 v67, v64, v43
    v_mul_f32 v55, v52, v45
    v_fma_f32 v66, -v65, v43, v66
    s_add_u32 m0, s27, 16384
    s_add_u32 s37, s26, 917504
    buffer_load_dwordx4 v2, s[8:11], s37 offen lds
    v_fma_f32 v54, -v53, v45, v54
    v_fma_f32 v67, v65, v42, v67
    v_fma_f32 v55, v53, v44, v55
    v_cvt_pk_bf16_f32 v196, v66, -v67
    s_add_u32 m0, s27, 1024
    s_add_u32 s31, s25, 512
    buffer_load_dwordx4 v3, s[4:7], s31 offen lds
    v_mul_f32 v56, v54, v44
    v_mul_f32 v68, v66, v42
    v_mul_f32 v57, v54, v45
    v_mul_f32 v69, v66, v43
    s_add_u32 m0, s27, 17408
    s_add_u32 s37, s26, 931840
    buffer_load_dwordx4 v2, s[8:11], s37 offen lds
    v_fma_f32 v56, -v55, v45, v56
    v_fma_f32 v68, -v67, v43, v68
    v_fma_f32 v57, v55, v44, v57
    v_fma_f32 v69, v67, v42, v69
    s_add_u32 m0, s27, 2048
    s_add_u32 s31, s25, 16896
    buffer_load_dwordx4 v1, s[4:7], s31 offen lds
    v_cvt_pk_bf16_f32 v197, v68, -v69
    v_mul_f32 v70, v68, v42
    v_mul_f32 v71, v68, v43
    v_fma_f32 v70, -v69, v43, v70
    s_add_u32 m0, s27, 18432
    s_add_u32 s37, s26, 946176
    buffer_load_dwordx4 v2, s[8:11], s37 offen lds
    v_fma_f32 v71, v69, v42, v71
    v_cvt_pk_bf16_f32 v198, v70, -v71
    v_mul_f32 v72, v70, v42
    v_mul_f32 v73, v70, v43
    s_add_u32 m0, s27, 3072
    s_add_u32 s31, s25, 16896
    buffer_load_dwordx4 v3, s[4:7], s31 offen lds
    v_fma_f32 v72, -v71, v43, v72
    v_fma_f32 v73, v71, v42, v73
    v_cvt_pk_bf16_f32 v199, v72, -v73
    v_mul_f32 v74, v72, v42
    s_add_u32 m0, s27, 19456
    s_add_u32 s37, s26, 960512
    buffer_load_dwordx4 v2, s[8:11], s37 offen lds
    v_mul_f32 v75, v72, v43
    v_fma_f32 v74, -v73, v43, v74
    v_fma_f32 v75, v73, v42, v75
    v_cvt_pk_bf16_f32 v200, v74, -v75
    s_waitcnt vmcnt(8)
    s_barrier
    s_add_u32 m0, s27, 32768
    s_add_u32 s31, s25, 640
    buffer_load_dwordx4 v1, s[4:7], s31 offen lds
    v_mul_f32 v76, v58, v44
    v_mul_f32 v80, v62, v44
    v_mul_f32 v77, v58, v45
    v_mul_f32 v81, v62, v45
    s_add_u32 m0, s27, 49152
    s_add_u32 s37, s26, 1146880
    buffer_load_dwordx4 v2, s[8:11], s37 offen lds
    v_fma_f32 v76, -v59, v45, v76
    v_fma_f32 v80, -v63, v45, v80
    v_fma_f32 v77, v59, v44, v77
    v_fma_f32 v81, v63, v44, v81
    s_add_u32 m0, s27, 33792
    s_add_u32 s31, s25, 640
    buffer_load_dwordx4 v3, s[4:7], s31 offen lds
    v_cvt_pk_bf16_f32 v201, v76, -v77
    v_cvt_pk_bf16_f32 v202, v80, -v81
    v_mul_f32 v78, v66, v44
    v_mul_f32 v82, v70, v44
    s_add_u32 m0, s27, 50176
    s_add_u32 s37, s26, 1161216
    buffer_load_dwordx4 v2, s[8:11], s37 offen lds
    v_mul_f32 v79, v66, v45
    v_mul_f32 v83, v70, v45
    v_fma_f32 v78, -v67, v45, v78
    v_fma_f32 v82, -v71, v45, v82
    s_add_u32 m0, s27, 34816
    s_add_u32 s31, s25, 17024
    buffer_load_dwordx4 v1, s[4:7], s31 offen lds
    v_fma_f32 v79, v67, v44, v79
    v_fma_f32 v83, v71, v44, v83
    v_cvt_pk_bf16_f32 v203, v78, -v79
    v_cvt_pk_bf16_f32 v204, v82, -v83
    s_add_u32 m0, s27, 51200
    s_add_u32 s37, s26, 1175552
    buffer_load_dwordx4 v2, s[8:11], s37 offen lds
    v_mul_f32 v76, v74, v44
    v_mul_f32 v80, v58, v46
    v_mul_f32 v77, v74, v45
    v_mul_f32 v81, v58, v47
    s_add_u32 m0, s27, 35840
    s_add_u32 s31, s25, 17024
    buffer_load_dwordx4 v3, s[4:7], s31 offen lds
    v_fma_f32 v76, -v75, v45, v76
    v_fma_f32 v80, -v59, v47, v80
    v_fma_f32 v77, v75, v44, v77
    v_fma_f32 v81, v59, v46, v81
    s_add_u32 m0, s27, 52224
    s_add_u32 s37, s26, 1189888
    buffer_load_dwordx4 v2, s[8:11], s37 offen lds
    v_cvt_pk_bf16_f32 v205, v76, -v77
    v_cvt_pk_bf16_f32 v206, v80, -v81
    v_mul_f32 v78, v66, v46
    v_mul_f32 v82, v74, v46
    s_waitcnt vmcnt(8)
    s_barrier
    s_add_u32 m0, s27, 65536
    s_add_u32 s31, s25, 768
    buffer_load_dwordx4 v1, s[4:7], s31 offen lds
    v_mul_f32 v79, v66, v47
    v_mul_f32 v83, v74, v47
    v_fma_f32 v78, -v67, v47, v78
    s_add_u32 m0, s27, 81920
    s_add_u32 s37, s26, 1376256
    buffer_load_dwordx4 v2, s[8:11], s37 offen lds
    v_fma_f32 v82, -v75, v47, v82
    v_fma_f32 v79, v67, v46, v79
    v_fma_f32 v83, v75, v46, v83
    v_cvt_pk_bf16_f32 v207, v78, -v79
    s_add_u32 m0, s27, 66560
    s_add_u32 s31, s25, 768
    buffer_load_dwordx4 v3, s[4:7], s31 offen lds
    v_cvt_pk_bf16_f32 v208, v82, -v83
    v_mul_f32 v76, v58, v48
    v_mul_f32 v80, v66, v48
    v_mul_f32 v77, v58, v49
    s_add_u32 m0, s27, 82944
    s_add_u32 s37, s26, 1390592
    buffer_load_dwordx4 v2, s[8:11], s37 offen lds
    v_mul_f32 v81, v66, v49
    v_fma_f32 v76, -v59, v49, v76
    v_fma_f32 v80, -v67, v49, v80
    v_fma_f32 v77, v59, v48, v77
    s_add_u32 m0, s27, 67584
    s_add_u32 s31, s25, 17152
    buffer_load_dwordx4 v1, s[4:7], s31 offen lds
    v_fma_f32 v81, v67, v48, v81
    v_cvt_pk_bf16_f32 v209, v76, -v77
    v_cvt_pk_bf16_f32 v210, v80, -v81
    v_mul_f32 v78, v74, v48
    s_add_u32 m0, s27, 83968
    s_add_u32 s37, s26, 1404928
    buffer_load_dwordx4 v2, s[8:11], s37 offen lds
    v_mul_f32 v82, v58, v50
    v_mul_f32 v79, v74, v49
    v_mul_f32 v83, v58, v51
    v_fma_f32 v78, -v75, v49, v78
    s_add_u32 m0, s27, 68608
    s_add_u32 s31, s25, 17152
    buffer_load_dwordx4 v3, s[4:7], s31 offen lds
    v_fma_f32 v82, -v59, v51, v82
    v_fma_f32 v79, v75, v48, v79
    v_fma_f32 v83, v59, v50, v83
    v_cvt_pk_bf16_f32 v211, v78, -v79
    s_add_u32 m0, s27, 84992
    s_add_u32 s37, s26, 1419264
    buffer_load_dwordx4 v2, s[8:11], s37 offen lds
    v_cvt_pk_bf16_f32 v212, v82, -v83
    v_mul_f32 v76, v74, v50
    v_mul_f32 v80, v58, v52
    v_mul_f32 v77, v74, v51
    s_waitcnt vmcnt(8)
    s_barrier
    s_add_u32 m0, s27, 98304
    s_add_u32 s31, s25, 896
    buffer_load_dwordx4 v1, s[4:7], s31 offen lds
    v_mul_f32 v81, v58, v53
    v_fma_f32 v76, -v75, v51, v76
    v_fma_f32 v80, -v59, v53, v80
    v_fma_f32 v77, v75, v50, v77
    s_add_u32 m0, s27, 114688
    s_add_u32 s37, s26, 1605632
    buffer_load_dwordx4 v2, s[8:11], s37 offen lds
    v_fma_f32 v81, v59, v52, v81
    v_cvt_pk_bf16_f32 v213, v76, -v77
    v_cvt_pk_bf16_f32 v214, v80, -v81
    v_mul_f32 v78, v74, v52
    s_add_u32 m0, s27, 99328
    s_add_u32 s31, s25, 896
    buffer_load_dwordx4 v3, s[4:7], s31 offen lds
    v_mul_f32 v82, v58, v54
    v_mul_f32 v79, v74, v53
    v_mul_f32 v83, v58, v55
    v_fma_f32 v78, -v75, v53, v78
    s_add_u32 m0, s27, 115712
    s_add_u32 s37, s26, 1619968
    buffer_load_dwordx4 v2, s[8:11], s37 offen lds
    v_fma_f32 v82, -v59, v55, v82
    v_fma_f32 v79, v75, v52, v79
    v_fma_f32 v83, v59, v54, v83
    v_cvt_pk_bf16_f32 v215, v78, -v79
    s_add_u32 m0, s27, 100352
    s_add_u32 s31, s25, 17280
    buffer_load_dwordx4 v1, s[4:7], s31 offen lds
    v_cvt_pk_bf16_f32 v216, v82, -v83
    v_mul_f32 v76, v74, v54
    v_mul_f32 v80, v58, v56
    v_mul_f32 v77, v74, v55
    s_add_u32 m0, s27, 116736
    s_add_u32 s37, s26, 1634304
    buffer_load_dwordx4 v2, s[8:11], s37 offen lds
    v_mul_f32 v81, v58, v57
    v_fma_f32 v76, -v75, v55, v76
    v_fma_f32 v80, -v59, v57, v80
    v_fma_f32 v77, v75, v54, v77
    s_add_u32 m0, s27, 101376
    s_add_u32 s31, s25, 17280
    buffer_load_dwordx4 v3, s[4:7], s31 offen lds
    v_fma_f32 v81, v59, v56, v81
    v_cvt_pk_bf16_f32 v217, v76, -v77
    v_cvt_pk_bf16_f32 v218, v80, -v81
    v_mul_f32 v78, v74, v56
    s_add_u32 m0, s27, 117760
    s_add_u32 s37, s26, 1648640
    buffer_load_dwordx4 v2, s[8:11], s37 offen lds
    v_mul_f32 v79, v74, v57
    v_fma_f32 v78, -v75, v57, v78
    v_fma_f32 v79, v75, v56, v79
    v_cvt_pk_bf16_f32 v219, v78, -v79
    s_waitcnt vmcnt(8)
    s_barrier
    v_lshrrev_b32 v28, 3, v0
    v_and_b32 v29, 7, v0
    v_lshlrev_b32 v28, 10, v28
    v_lshlrev_b32 v29, 4, v29
    v_add_u32 v28, v28, v29
    s_lshl_b32 s29, s78, 6
    s_lshl_b32 s28, s20, 3
    s_add_u32 s29, s29, s28
    s_lshl_b32 s29, s29, 10
    s_lshl_b32 s30, s79, 7
    s_add_u32 s29, s29, s30
    s_mov_b32 s8, s50
    s_mov_b32 s9, s51
    s_mov_b32 s10, 1024
    s_mov_b32 s11, 0x00020000
    buffer_load_dwordx4 v[4:7], v28, s[4:7], s29 offen
    buffer_load_dwordx4 v[8:11], v29, s[8:11], s30 offen
    s_add_u32 s31, s74, 0
    s_sub_u32 s75, s31, 28672
    s_min_u32 s31, s31, s75
    s_add_u32 m0, s73, 0
    s_lshl4_add_u32 s31, s31, s72
    buffer_load_dwordx4 v23, s[16:19], s31 offen lds
    s_add_u32 m0, s73, 1024
    s_add_u32 s31, s31, 8192
    buffer_load_dwordx4 v23, s[16:19], s31 offen lds
    s_add_u32 s31, s74, 1024
    s_sub_u32 s75, s31, 28672
    s_min_u32 s31, s31, s75
    s_add_u32 m0, s73, 2048
    s_lshl4_add_u32 s31, s31, s72
    buffer_load_dwordx4 v23, s[16:19], s31 offen lds
    s_add_u32 m0, s73, 3072
    s_add_u32 s31, s31, 8192
    buffer_load_dwordx4 v23, s[16:19], s31 offen lds
    s_waitcnt vmcnt(6)
    s_barrier
    s_add_u32 s31, s74, 2048
    s_sub_u32 s75, s31, 28672
    s_min_u32 s31, s31, s75
    s_add_u32 m0, s73, 4096
    s_lshl4_add_u32 s31, s31, s72
    buffer_load_dwordx4 v23, s[16:19], s31 offen lds
    s_add_u32 m0, s73, 5120
    s_add_u32 s31, s31, 8192
    buffer_load_dwordx4 v23, s[16:19], s31 offen lds
    s_add_u32 s31, s74, 3072
    s_sub_u32 s75, s31, 28672
    s_min_u32 s31, s31, s75
    s_add_u32 m0, s73, 6144
    s_lshl4_add_u32 s31, s31, s72
    buffer_load_dwordx4 v23, s[16:19], s31 offen lds
    s_add_u32 m0, s73, 7168
    s_add_u32 s31, s31, 8192
    buffer_load_dwordx4 v23, s[16:19], s31 offen lds
    s_add_u32 s31, s74, 4096
    s_sub_u32 s75, s31, 28672
    s_min_u32 s31, s31, s75
    s_add_u32 m0, s73, 32768
    s_lshl4_add_u32 s31, s31, s72
    buffer_load_dwordx4 v23, s[16:19], s31 offen lds
    s_add_u32 m0, s73, 33792
    s_add_u32 s31, s31, 8192
    buffer_load_dwordx4 v23, s[16:19], s31 offen lds
    s_add_u32 s31, s74, 5120
    s_sub_u32 s75, s31, 28672
    s_min_u32 s31, s31, s75
    s_add_u32 m0, s73, 34816
    s_lshl4_add_u32 s31, s31, s72
    buffer_load_dwordx4 v23, s[16:19], s31 offen lds
    s_add_u32 m0, s73, 35840
    s_add_u32 s31, s31, 8192
    buffer_load_dwordx4 v23, s[16:19], s31 offen lds
    s_add_u32 s31, s74, 6144
    s_sub_u32 s75, s31, 28672
    s_min_u32 s31, s31, s75
    s_add_u32 m0, s73, 36864
    s_lshl4_add_u32 s31, s31, s72
    buffer_load_dwordx4 v23, s[16:19], s31 offen lds
    s_add_u32 m0, s73, 37888
    s_add_u32 s31, s31, 8192
    buffer_load_dwordx4 v23, s[16:19], s31 offen lds
    s_add_u32 s31, s74, 7168
    s_sub_u32 s75, s31, 28672
    s_min_u32 s31, s31, s75
    s_add_u32 m0, s73, 38912
    s_lshl4_add_u32 s31, s31, s72
    buffer_load_dwordx4 v23, s[16:19], s31 offen lds
    s_add_u32 m0, s73, 39936
    s_add_u32 s31, s31, 8192
    buffer_load_dwordx4 v23, s[16:19], s31 offen lds
    v_mov_b32 v30, 157312
L_h_rd:
    ds_read_b128 v[32:35], v30
    s_waitcnt lgkmcnt(0)
    v_and_b32 v32, v32, v33
    v_and_b32 v34, v34, v35
    v_and_b32 v32, v32, v34
    s_nop 0
    v_readfirstlane_b32 s28, v32
    s_nop 0
    s_cmp_eq_u32 s28, 1
    s_cbranch_scc0 L_h_rd
    s_add_u32 s31, s74, 8192
    s_sub_u32 s75, s31, 28672
    s_min_u32 s31, s31, s75
    s_add_u32 m0, s73, 65536
    s_lshl4_add_u32 s31, s31, s72
    buffer_load_dwordx4 v23, s[16:19], s31 offen lds
    s_add_u32 m0, s73, 66560
    s_add_u32 s31, s31, 8192
    buffer_load_dwordx4 v23, s[16:19], s31 offen lds
    s_add_u32 s31, s74, 9216
    s_sub_u32 s75, s31, 28672
    s_min_u32 s31, s31, s75
    s_add_u32 m0, s73, 67584
    s_lshl4_add_u32 s31, s31, s72
    buffer_load_dwordx4 v23, s[16:19], s31 offen lds
    s_add_u32 m0, s73, 68608
    s_add_u32 s31, s31, 8192
    buffer_load_dwordx4 v23, s[16:19], s31 offen lds
    s_add_u32 s31, s74, 10240
    s_sub_u32 s75, s31, 28672
    s_min_u32 s31, s31, s75
    s_add_u32 m0, s73, 69632
    s_lshl4_add_u32 s31, s31, s72
    buffer_load_dwordx4 v23, s[16:19], s31 offen lds
    s_add_u32 m0, s73, 70656
    s_add_u32 s31, s31, 8192
    buffer_load_dwordx4 v23, s[16:19], s31 offen lds
    s_add_u32 s31, s74, 11264
    s_sub_u32 s75, s31, 28672
    s_min_u32 s31, s31, s75
    s_add_u32 m0, s73, 71680
    s_lshl4_add_u32 s31, s31, s72
    buffer_load_dwordx4 v23, s[16:19], s31 offen lds
    s_add_u32 m0, s73, 72704
    s_add_u32 s31, s31, 8192
    buffer_load_dwordx4 v23, s[16:19], s31 offen lds
L_h_tail:
    s_setprio 0
    ds_write_b32 v100, v192 offset:0
    ds_write_b32 v101, v193 offset:256
    ds_write_b32 v102, v194 offset:512
    ds_write_b32 v103, v195 offset:768
    ds_write_b32 v108, v196 offset:2048
    ds_write_b32 v109, v197 offset:2304
    ds_write_b32 v110, v198 offset:2560
    ds_write_b32 v111, v199 offset:2816
    ds_write_b32 v100, v200 offset:4096
    ds_write_b32 v104, v201 offset:1024
    ds_write_b32 v105, v201 offset:1280
    ds_write_b32 v106, v202 offset:1536
    ds_write_b32 v107, v203 offset:1792
    ds_write_b32 v112, v203 offset:3072
    ds_write_b32 v113, v203 offset:3328
    ds_write_b32 v114, v204 offset:3584
    ds_write_b32 v115, v205 offset:3840
    ds_write_b32 v104, v205 offset:5120
    ds_write_b32 v101, v206 offset:4352
    ds_write_b32 v102, v207 offset:4608
    ds_write_b32 v103, v208 offset:4864
    ds_write_b32 v105, v209 offset:5376
    ds_write_b32 v106, v210 offset:5632
    ds_write_b32 v107, v211 offset:5888
    ds_write_b32 v108, v212 offset:6144
    ds_write_b32 v109, v213 offset:6400
    ds_write_b32 v110, v214 offset:6656
    ds_write_b32 v111, v215 offset:6912
    ds_write_b32 v112, v216 offset:7168
    ds_write_b32 v113, v217 offset:7424
    ds_write_b32 v114, v218 offset:7680
    ds_write_b32 v115, v219 offset:7936
    ds_read_b128 v[192:195], v116 offset:0
    ds_read_b128 v[196:199], v117 offset:0
    ds_read_b128 v[200:203], v118 offset:0
    ds_read_b128 v[204:207], v119 offset:0
    ds_read_b128 v[208:211], v120 offset:0
    ds_read_b128 v[212:215], v121 offset:0
    ds_read_b128 v[216:219], v122 offset:0
    ds_read_b128 v[220:223], v123 offset:0
    s_waitcnt lgkmcnt(7)
    v_mfma_f32_32x32x16_bf16 v[224:239], v[192:195], v[160:163], 0
    s_waitcnt lgkmcnt(6)
    v_mfma_f32_32x32x16_bf16 v[224:239], v[196:199], v[164:167], v[224:239]
    s_waitcnt lgkmcnt(5)
    v_mfma_f32_32x32x16_bf16 v[224:239], v[200:203], v[168:171], v[224:239]
    s_waitcnt lgkmcnt(4)
    v_mfma_f32_32x32x16_bf16 v[224:239], v[204:207], v[172:175], v[224:239]
    s_waitcnt lgkmcnt(3)
    v_mfma_f32_32x32x16_bf16 v[224:239], v[208:211], v[176:179], v[224:239]
    s_waitcnt lgkmcnt(2)
    v_mfma_f32_32x32x16_bf16 v[224:239], v[212:215], v[180:183], v[224:239]
    s_waitcnt lgkmcnt(1)
    v_mfma_f32_32x32x16_bf16 v[224:239], v[216:219], v[184:187], v[224:239]
    s_waitcnt lgkmcnt(0)
    v_mfma_f32_32x32x16_bf16 v[224:239], v[220:223], v[188:191], v[224:239]
    s_bitcmp1_b32 s39, 0
    s_cselect_b64 exec, -1, 0
    s_nop 9
    ds_write_b128 v146, v[224:227] offset:512
    ds_write_b128 v146, v[228:231] offset:1536
    ds_write_b128 v146, v[232:235] offset:2560
    s_not_b64 exec, exec
    ds_write_b128 v146, v[236:239] offset:3584
    s_mov_b64 exec, -1
    ds_write_b32 v149, v152 offset:80
    buffer_load_dword v253, v154, s[12:15], 0 offen sc1
L_h_x1:
    ds_read_b32 v32, v153 offset:80
    s_waitcnt lgkmcnt(0)
    v_readfirstlane_b32 s28, v32
    s_nop 0
    s_cmp_eq_u32 s28, 1
    s_cbranch_scc0 L_h_x1
    s_bitcmp1_b32 s39, 0
    s_cbranch_scc1 L_xog
    ds_read_b128 v[128:131], v147 offset:512
    ds_read_b128 v[132:135], v147 offset:1536
    ds_read_b128 v[136:139], v147 offset:2560
    s_waitcnt lgkmcnt(2)
    v_add_f32 v224, v224, v128
    v_add_f32 v225, v225, v129
    v_add_f32 v226, v226, v130
    v_add_f32 v227, v227, v131
    s_waitcnt lgkmcnt(1)
    v_add_f32 v228, v228, v132
    v_add_f32 v229, v229, v133
    v_add_f32 v230, v230, v134
    v_add_f32 v231, v231, v135
    s_waitcnt lgkmcnt(0)
    v_add_f32 v232, v232, v136
    v_add_f32 v233, v233, v137
    v_add_f32 v234, v234, v138
    v_add_f32 v235, v235, v139
    v_cvt_pk_bf16_f32 v160, v231, v230
    v_cvt_pk_bf16_f32 v161, v229, v228
    v_cvt_pk_bf16_f32 v162, v227, v226
    v_cvt_pk_bf16_f32 v163, v225, v224
    ds_write_b128 v254, v[160:163] offset:1024
    v_cvt_pk_bf16_f32 v164, v232, v231
    v_cvt_pk_bf16_f32 v165, v230, v229
    v_cvt_pk_bf16_f32 v166, v228, v227
    v_cvt_pk_bf16_f32 v167, v226, v225
    ds_write_b128 v254, v[164:167] offset:5184
    v_cvt_pk_bf16_f32 v168, v235, v235
    v_cvt_pk_bf16_f32 v169, v234, v234
    v_cvt_pk_bf16_f32 v170, v234, v233
    v_cvt_pk_bf16_f32 v171, v233, v233
    ds_write_b128 v254, v[168:171] offset:0
    v_cvt_pk_bf16_f32 v172, v235, v235
    v_cvt_pk_bf16_f32 v173, v235, v234
    v_cvt_pk_bf16_f32 v174, v234, v234
    v_cvt_pk_bf16_f32 v175, v233, v233
    ds_write_b128 v254, v[172:175] offset:4160
    s_mov_b64 exec, 1
    ds_write_b16_d16_hi v148, v163 offset:12864
    s_mov_b64 exec, -1
    s_branch L_xdg
L_xog:
    ds_read_b128 v[140:143], v147 offset:3584
    s_mov_b32 s28, 0xaaaaaaaa
    s_mov_b32 s29, 0xaaaaaaaa
    s_waitcnt lgkmcnt(0)
    v_add_f32 v236, v236, v140
    v_add_f32 v237, v237, v141
    v_add_f32 v238, v238, v142
    v_add_f32 v239, v239, v143
    v_cndmask_b32 v128, v236, v237, s[28:29]
    v_cndmask_b32 v129, v238, v239, s[28:29]
    v_cvt_pk_bf16_f32 v160, v237, v237
    v_cvt_pk_bf16_f32 v161, v237, v128
    v_cvt_pk_bf16_f32 v162, v236, v236
    v_cvt_pk_bf16_f32 v163, v236, v236
    ds_write_b128 v255, v[160:163] offset:512
    v_cvt_pk_bf16_f32 v164, v237, v237
    v_cvt_pk_bf16_f32 v165, v237, v237
    v_cvt_pk_bf16_f32 v166, v128, v236
    v_cvt_pk_bf16_f32 v167, v236, v236
    ds_write_b128 v255, v[164:167] offset:4672
    v_cvt_pk_bf16_f32 v168, v239, v239
    v_cvt_pk_bf16_f32 v169, v239, v129
    v_cvt_pk_bf16_f32 v170, v238, v238
    v_cvt_pk_bf16_f32 v171, v238, v238
    ds_write_b128 v255, v[168:171] offset:0
    v_cvt_pk_bf16_f32 v172, v239, v239
    v_cvt_pk_bf16_f32 v173, v239, v239
    v_cvt_pk_bf16_f32 v174, v129, v238
    v_cvt_pk_bf16_f32 v175, v238, v238
    ds_write_b128 v255, v[172:175] offset:4160
L_xdg:
    ds_write_b32 v149, v152 offset:64
    s_setprio 0
    v_lshlrev_b32 v18, 4, v0
    s_waitcnt vmcnt(0)
    s_mov_b32 s30, 0
    v_cmp_ne_u32 vcc, s76, v253
    s_nop 0
    s_cbranch_vccz L_rt_ok
L_rt:
    s_sleep 8
    buffer_load_dword v253, v154, s[12:15], 0 offen sc1
    s_add_u32 s30, s30, 1
    s_waitcnt vmcnt(0)
    v_cmp_ne_u32 vcc, s76, v253
    s_cmp_ge_u32 s30, 6
    s_cbranch_scc1 L_rt_ok
    s_cbranch_vccnz L_rt
L_rt_ok:
    v_cmp_ne_u32 vcc, s76, v253
    s_mov_b32 s37, 0
    s_cbranch_vccnz L_ut_no
    s_mov_b32 s37, 1
    s_lshr_b32 s28, s39, 1
    s_lshl_b32 s29, s2, 1
    s_add_u32 s29, s29, s28
    s_lshl_b32 s29, s29, 7
    s_add_u32 s29, s29, 8388608
    s_mul_i32 s28, s28, 13056
    s_add_u32 m0, s28, 131584
    v_lshrrev_b32 v180, 3, v0
    v_and_b32 v181, 7, v0
    v_mul_u32_u24 v180, 67712, v180
    v_lshl_add_u32 v180, v181, 4, v180
    buffer_load_dwordx4 v180, s[12:15], s29 offen offset:0 sc1 lds
    s_add_u32 s29, s29, 540672
    buffer_load_dwordx4 v180, s[12:15], s29 offen offset:1024 sc1 lds
    s_add_u32 s29, s29, 540672
    buffer_load_dwordx4 v180, s[12:15], s29 offen offset:2048 sc1 lds
    s_add_u32 s29, s29, 540672
    buffer_load_dwordx4 v180, s[12:15], s29 offen offset:3072 sc1 lds
L_ut_no:
    ds_write_b32 v149, v152 offset:16
    s_branch L_conv
L_ln_H2:
    s_waitcnt vmcnt(0)
    ds_write_b32 v5, v6
    s_waitcnt lgkmcnt(0)
    v_lshrrev_b32 v28, 3, v0
    v_and_b32 v29, 7, v0
    v_lshlrev_b32 v28, 10, v28
    v_lshlrev_b32 v29, 4, v29
    v_add_u32 v28, v28, v29
    s_lshl_b32 s29, s78, 6
    s_lshl_b32 s28, s20, 3
    s_add_u32 s29, s29, s28
    s_lshl_b32 s29, s29, 10
    s_lshl_b32 s30, s79, 7
    s_add_u32 s29, s29, s30
    s_mov_b32 s8, s50
    s_mov_b32 s9, s51
    s_mov_b32 s10, 1024
    s_mov_b32 s11, 0x00020000
    buffer_load_dwordx4 v[4:7], v28, s[4:7], s29 offen
    buffer_load_dwordx4 v[8:11], v29, s[8:11], s30 offen
    v_exp_f32 v36, v144
    v_mul_f32 v38, 0x43800000, v144
    v_mul_f32 v58, v248, v246
    v_fract_f32 v37, v145
    v_mul_f32 v39, 0x43800000, v145
    v_mul_f32 v59, v248, v247
    v_cos_f32 v42, v37
    v_exp_f32 v38, v38
    v_fma_f32 v58, -v249, v247, v58
    v_sin_f32 v43, v37
    v_fract_f32 v39, v39
    v_fma_f32 v59, v249, v246, v59
    v_mul_f32 v42, v42, v36
    v_cos_f32 v44, v39
    v_mul_f32 v43, v43, v36
    v_sin_f32 v45, v39
    v_mul_f32 v44, v44, v38
    v_mul_f32 v45, v45, v38
    v_cvt_pk_bf16_f32 v192, v58, -v59
    v_mul_f32 v46, v44, v44
    v_mul_f32 v60, v58, v42
    v_mul_f32 v47, v44, v45
    v_mul_f32 v61, v58, v43
    v_fma_f32 v46, -v45, v45, v46
    v_fma_f32 v60, -v59, v43, v60
    v_fma_f32 v47, v45, v44, v47
    v_fma_f32 v61, v59, v42, v61
    v_mul_f32 v48, v46, v44
    v_cvt_pk_bf16_f32 v193, v60, -v61
    v_mul_f32 v49, v46, v45
    v_mul_f32 v62, v60, v42
    v_fma_f32 v48, -v47, v45, v48
    v_mul_f32 v63, v60, v43
    v_fma_f32 v49, v47, v44, v49
    v_fma_f32 v62, -v61, v43, v62
    v_mul_f32 v50, v48, v44
    v_fma_f32 v63, v61, v42, v63
    v_mul_f32 v51, v48, v45
    v_cvt_pk_bf16_f32 v194, v62, -v63
    v_fma_f32 v50, -v49, v45, v50
    v_mul_f32 v64, v62, v42
    v_fma_f32 v51, v49, v44, v51
    v_mul_f32 v65, v62, v43
    v_mul_f32 v52, v50, v44
    v_fma_f32 v64, -v63, v43, v64
    v_mul_f32 v53, v50, v45
    v_fma_f32 v65, v63, v42, v65
    v_fma_f32 v52, -v51, v45, v52
    v_cvt_pk_bf16_f32 v195, v64, -v65
    v_fma_f32 v53, v51, v44, v53
    v_mul_f32 v66, v64, v42
    v_mul_f32 v54, v52, v44
    v_mul_f32 v67, v64, v43
    v_mul_f32 v55, v52, v45
    v_fma_f32 v66, -v65, v43, v66
    v_fma_f32 v54, -v53, v45, v54
    v_fma_f32 v67, v65, v42, v67
    v_fma_f32 v55, v53, v44, v55
    v_cvt_pk_bf16_f32 v196, v66, -v67
    v_mul_f32 v56, v54, v44
    v_mul_f32 v68, v66, v42
    v_mul_f32 v57, v54, v45
    v_mul_f32 v69, v66, v43
    v_fma_f32 v56, -v55, v45, v56
    v_fma_f32 v68, -v67, v43, v68
    v_fma_f32 v57, v55, v44, v57
    v_fma_f32 v69, v67, v42, v69
    v_cvt_pk_bf16_f32 v197, v68, -v69
    v_mul_f32 v70, v68, v42
    v_mul_f32 v71, v68, v43
    v_fma_f32 v70, -v69, v43, v70
    v_fma_f32 v71, v69, v42, v71
    v_cvt_pk_bf16_f32 v198, v70, -v71
    v_mul_f32 v72, v70, v42
    v_mul_f32 v73, v70, v43
    v_fma_f32 v72, -v71, v43, v72
    v_fma_f32 v73, v71, v42, v73
    v_cvt_pk_bf16_f32 v199, v72, -v73
    v_mul_f32 v74, v72, v42
    v_mul_f32 v75, v72, v43
    v_fma_f32 v74, -v73, v43, v74
    v_fma_f32 v75, v73, v42, v75
    v_cvt_pk_bf16_f32 v200, v74, -v75
    v_mul_f32 v76, v58, v44
    v_mul_f32 v80, v62, v44
    v_mul_f32 v77, v58, v45
    v_mul_f32 v81, v62, v45
    v_fma_f32 v76, -v59, v45, v76
    v_fma_f32 v80, -v63, v45, v80
    v_fma_f32 v77, v59, v44, v77
    v_fma_f32 v81, v63, v44, v81
    v_cvt_pk_bf16_f32 v201, v76, -v77
    v_cvt_pk_bf16_f32 v202, v80, -v81
    v_mul_f32 v78, v66, v44
    v_mul_f32 v82, v70, v44
    v_mul_f32 v79, v66, v45
    v_mul_f32 v83, v70, v45
    v_fma_f32 v78, -v67, v45, v78
    v_fma_f32 v82, -v71, v45, v82
    v_fma_f32 v79, v67, v44, v79
    v_fma_f32 v83, v71, v44, v83
    v_cvt_pk_bf16_f32 v203, v78, -v79
    v_cvt_pk_bf16_f32 v204, v82, -v83
    v_mul_f32 v76, v74, v44
    v_mul_f32 v80, v58, v46
    v_mul_f32 v77, v74, v45
    v_mul_f32 v81, v58, v47
    v_fma_f32 v76, -v75, v45, v76
    v_fma_f32 v80, -v59, v47, v80
    v_fma_f32 v77, v75, v44, v77
    v_fma_f32 v81, v59, v46, v81
    v_cvt_pk_bf16_f32 v205, v76, -v77
    v_cvt_pk_bf16_f32 v206, v80, -v81
    v_mul_f32 v78, v66, v46
    v_mul_f32 v82, v74, v46
    v_mul_f32 v79, v66, v47
    v_mul_f32 v83, v74, v47
    v_fma_f32 v78, -v67, v47, v78
    v_fma_f32 v82, -v75, v47, v82
    v_fma_f32 v79, v67, v46, v79
    v_fma_f32 v83, v75, v46, v83
    v_cvt_pk_bf16_f32 v207, v78, -v79
    v_cvt_pk_bf16_f32 v208, v82, -v83
    v_mul_f32 v76, v58, v48
    v_mul_f32 v80, v66, v48
    v_mul_f32 v77, v58, v49
    v_mul_f32 v81, v66, v49
    v_fma_f32 v76, -v59, v49, v76
    v_fma_f32 v80, -v67, v49, v80
    v_fma_f32 v77, v59, v48, v77
    v_fma_f32 v81, v67, v48, v81
    v_cvt_pk_bf16_f32 v209, v76, -v77
    v_cvt_pk_bf16_f32 v210, v80, -v81
    v_mul_f32 v78, v74, v48
    v_mul_f32 v82, v58, v50
    v_mul_f32 v79, v74, v49
    v_mul_f32 v83, v58, v51
    v_fma_f32 v78, -v75, v49, v78
    v_fma_f32 v82, -v59, v51, v82
    v_fma_f32 v79, v75, v48, v79
    v_fma_f32 v83, v59, v50, v83
    v_cvt_pk_bf16_f32 v211, v78, -v79
    v_cvt_pk_bf16_f32 v212, v82, -v83
    v_mul_f32 v76, v74, v50
    v_mul_f32 v80, v58, v52
    v_mul_f32 v77, v74, v51
    v_mul_f32 v81, v58, v53
    v_fma_f32 v76, -v75, v51, v76
    v_fma_f32 v80, -v59, v53, v80
    v_fma_f32 v77, v75, v50, v77
    v_fma_f32 v81, v59, v52, v81
    v_cvt_pk_bf16_f32 v213, v76, -v77
    v_cvt_pk_bf16_f32 v214, v80, -v81
    v_mul_f32 v78, v74, v52
    v_mul_f32 v82, v58, v54
    v_mul_f32 v79, v74, v53
    v_mul_f32 v83, v58, v55
    v_fma_f32 v78, -v75, v53, v78
    v_fma_f32 v82, -v59, v55, v82
    v_fma_f32 v79, v75, v52, v79
    v_fma_f32 v83, v59, v54, v83
    v_cvt_pk_bf16_f32 v215, v78, -v79
    v_cvt_pk_bf16_f32 v216, v82, -v83
    v_mul_f32 v76, v74, v54
    v_mul_f32 v80, v58, v56
    v_mul_f32 v77, v74, v55
    v_mul_f32 v81, v58, v57
    v_fma_f32 v76, -v75, v55, v76
    v_fma_f32 v80, -v59, v57, v80
    v_fma_f32 v77, v75, v54, v77
    v_fma_f32 v81, v59, v56, v81
    v_cvt_pk_bf16_f32 v217, v76, -v77
    v_cvt_pk_bf16_f32 v218, v80, -v81
    v_mul_f32 v78, v74, v56
    v_mul_f32 v79, v74, v57
    v_fma_f32 v78, -v75, v57, v78
    v_fma_f32 v79, v75, v56, v79
    v_cvt_pk_bf16_f32 v219, v78, -v79
    s_lshr_b32 s30, s39, 1
    s_mul_i32 s30, s30, 13056
    s_add_u32 s38, s30, 131072
    s_lshl_b32 s30, s39, 13
    s_add_u32 s30, s30, 98304
    v_lshl_add_u32 v146, v0, 4, s30
    v_xor_b32 v147, 8192, v146
    v_and_b32 v28, 31, v0
    v_lshrrev_b32 v29, 5, v0
    v_lshlrev_b32 v30, 4, v28
    s_add_u32 s28, s38, 7664
    v_sub_u32 v254, s28, v30
    v_lshlrev_b32 v31, 9, v29
    v_sub_u32 v254, v254, v31
    s_add_u32 s28, s38, 6128
    v_sub_u32 v255, s28, v30
    v_lshlrev_b32 v31, 10, v29
    v_sub_u32 v255, v255, v31
    v_lshl_add_u32 v148, v0, 3, s38
    v_mov_b32 v150, 0
    v_mov_b32 v151, 0
    v_mov_b32 v152, 1
    s_lshl_b32 s28, s39, 2
    s_add_u32 s28, s28, 157184
    v_mov_b32 v149, s28
    v_xor_b32 v153, 4, v149
    s_lshl_b32 s29, s79, 6
    s_lshl_b32 s28, s39, 4
    s_add_u32 s29, s29, s28
    s_lshr_b32 s28, s78, 4
    s_lshl_b32 s28, s28, 9
    s_add_u32 s29, s29, s28
    s_lshl_b32 s29, s29, 2
    s_add_u32 s29, s29, 262144
    v_lshlrev_b32 v154, 2, v0
    v_add_u32 v154, 32768, v154
    v_and_b32 v155, 15, v0
    v_lshl_add_u32 v155, v155, 2, s29
    s_mov_b32 s28, 0
    s_mov_b32 s29, -1
    v_cndmask_b32 v154, v154, v155, s[28:29]
    s_bitcmp0_b32 s39, 0
    s_cselect_b64 s[28:29], -1, 0
    s_mov_b64 exec, s[28:29]
    ds_write_b64 v148, v[150:151]
    s_and_b64 exec, s[28:29], 15
    ds_write_b64 v148, v[150:151] offset:8704
    ds_write_b64 v148, v[150:151] offset:12864
    s_mov_b64 exec, -1
    v_mov_b32 v30, 157360
L_ln_hv:
    ds_read_b128 v[32:35], v30
    s_waitcnt lgkmcnt(0)
    v_and_b32 v32, v32, v33
    v_and_b32 v34, v34, v35
    v_and_b32 v32, v32, v34
    s_nop 0
    v_readfirstlane_b32 s28, v32
    s_nop 0
    s_cmp_eq_u32 s28, 1
    s_cbranch_scc0 L_ln_hv
    s_branch L_h_tail
L_ln:
    s_nop 0
    s_mov_b32 s21, s78
    s_load_dwordx8 s[56:63], s[0:1], 8
    s_load_dwordx8 s[64:71], s[0:1], 40
    v_lshrrev_b32 v1, 3, v0
    v_and_b32 v2, 7, v0
    v_lshlrev_b32 v3, 10, v1
    v_lshl_add_u32 v3, v2, 4, v3
    v_lshlrev_b32 v4, 4, v0
    s_lshl_b32 s25, s21, 6
    s_lshl_b32 s28, s20, 3
    s_add_u32 s25, s25, s28
    s_lshl_b32 s36, s25, 3
    s_add_u32 s36, s36, 65536
    s_lshl_b32 s25, s25, 10
    s_add_u32 s26, s25, 4096
    s_waitcnt lgkmcnt(0)
    s_add_u32 s42, s42, 0
    s_addc_u32 s43, s43, 0
    s_load_dword s76, s[42:43], 49152
    s_mov_b32 s4, s40
    s_mov_b32 s5, s41
    s_mov_b32 s6, 2097152
    s_mov_b32 s7, 0x00020000
    buffer_load_dwordx4 v[48:51], v4, s[4:7], s25 offen offset:0
    buffer_load_dwordx4 v[52:55], v4, s[4:7], s25 offen offset:1024
    buffer_load_dwordx4 v[56:59], v4, s[4:7], s25 offen offset:2048
    buffer_load_dwordx4 v[60:63], v4, s[4:7], s25 offen offset:3072
    buffer_load_dwordx4 v[64:67], v4, s[4:7], s26 offen offset:0
    buffer_load_dwordx4 v[68:71], v4, s[4:7], s26 offen offset:1024
    buffer_load_dwordx4 v[72:75], v4, s[4:7], s26 offen offset:2048
    buffer_load_dwordx4 v[76:79], v4, s[4:7], s26 offen offset:3072
    s_mov_b32 s12, s42
    s_mov_b32 s13, s43
    s_mov_b32 s14, 14680064
    s_mov_b32 s15, 0x00020000
    v_mov_b32 v5, 0x3f803f80
    v_mov_b32 v14, 0x00003f80
    v_mov_b32 v15, 0x3f800000
    v_lshlrev_b32 v8, 3, v1
    s_setprio 2
    s_waitcnt vmcnt(7)
    v_dot2_f32_bf16 v16, v48, v5, 0
    v_dot2_f32_bf16 v24, v48, v48, 0
    v_dot2_f32_bf16 v16, v49, v5, v16
    v_dot2_f32_bf16 v24, v49, v49, v24
    v_dot2_f32_bf16 v16, v50, v5, v16
    v_dot2_f32_bf16 v24, v50, v50, v24
    v_dot2_f32_bf16 v16, v51, v5, v16
    v_dot2_f32_bf16 v24, v51, v51, v24
    s_waitcnt vmcnt(6)
    v_dot2_f32_bf16 v17, v52, v5, 0
    v_dot2_f32_bf16 v25, v52, v52, 0
    v_dot2_f32_bf16 v17, v53, v5, v17
    v_dot2_f32_bf16 v25, v53, v53, v25
    v_dot2_f32_bf16 v17, v54, v5, v17
    v_dot2_f32_bf16 v25, v54, v54, v25
    v_dot2_f32_bf16 v17, v55, v5, v17
    v_dot2_f32_bf16 v25, v55, v55, v25
    s_waitcnt vmcnt(5)
    v_dot2_f32_bf16 v18, v56, v5, 0
    v_dot2_f32_bf16 v26, v56, v56, 0
    v_dot2_f32_bf16 v18, v57, v5, v18
    v_dot2_f32_bf16 v26, v57, v57, v26
    v_dot2_f32_bf16 v18, v58, v5, v18
    v_dot2_f32_bf16 v26, v58, v58, v26
    v_dot2_f32_bf16 v18, v59, v5, v18
    v_dot2_f32_bf16 v26, v59, v59, v26
    s_waitcnt vmcnt(4)
    v_dot2_f32_bf16 v19, v60, v5, 0
    v_dot2_f32_bf16 v27, v60, v60, 0
    v_dot2_f32_bf16 v19, v61, v5, v19
    v_dot2_f32_bf16 v27, v61, v61, v27
    v_dot2_f32_bf16 v19, v62, v5, v19
    v_dot2_f32_bf16 v27, v62, v62, v27
    v_dot2_f32_bf16 v19, v63, v5, v19
    v_dot2_f32_bf16 v27, v63, v63, v27
    s_waitcnt vmcnt(3)
    v_dot2_f32_bf16 v20, v64, v5, 0
    v_dot2_f32_bf16 v28, v64, v64, 0
    v_dot2_f32_bf16 v20, v65, v5, v20
    v_dot2_f32_bf16 v28, v65, v65, v28
    v_dot2_f32_bf16 v20, v66, v5, v20
    v_dot2_f32_bf16 v28, v66, v66, v28
    v_dot2_f32_bf16 v20, v67, v5, v20
    v_dot2_f32_bf16 v28, v67, v67, v28
    s_waitcnt vmcnt(2)
    v_dot2_f32_bf16 v21, v68, v5, 0
    v_dot2_f32_bf16 v29, v68, v68, 0
    v_dot2_f32_bf16 v21, v69, v5, v21
    v_dot2_f32_bf16 v29, v69, v69, v29
    v_dot2_f32_bf16 v21, v70, v5, v21
    v_dot2_f32_bf16 v29, v70, v70, v29
    v_dot2_f32_bf16 v21, v71, v5, v21
    v_dot2_f32_bf16 v29, v71, v71, v29
    s_waitcnt vmcnt(1)
    v_dot2_f32_bf16 v22, v72, v5, 0
    v_dot2_f32_bf16 v30, v72, v72, 0
    v_dot2_f32_bf16 v22, v73, v5, v22
    v_dot2_f32_bf16 v30, v73, v73, v30
    v_dot2_f32_bf16 v22, v74, v5, v22
    v_dot2_f32_bf16 v30, v74, v74, v30
    v_dot2_f32_bf16 v22, v75, v5, v22
    v_dot2_f32_bf16 v30, v75, v75, v30
    s_waitcnt vmcnt(0)
    v_dot2_f32_bf16 v23, v76, v5, 0
    v_dot2_f32_bf16 v31, v76, v76, 0
    v_dot2_f32_bf16 v23, v77, v5, v23
    v_dot2_f32_bf16 v31, v77, v77, v31
    v_dot2_f32_bf16 v23, v78, v5, v23
    v_dot2_f32_bf16 v31, v78, v78, v31
    v_dot2_f32_bf16 v23, v79, v5, v23
    v_dot2_f32_bf16 v31, v79, v79, v31
    v_permlane32_swap_b32 v16, v20
    v_permlane32_swap_b32 v24, v28
    v_permlane32_swap_b32 v17, v21
    v_permlane32_swap_b32 v25, v29
    v_permlane32_swap_b32 v18, v22
    v_permlane32_swap_b32 v26, v30
    v_permlane32_swap_b32 v19, v23
    v_permlane32_swap_b32 v27, v31
    v_add_f32 v16, v16, v20
    v_add_f32 v24, v24, v28
    v_add_f32 v17, v17, v21
    v_add_f32 v25, v25, v29
    v_add_f32 v18, v18, v22
    v_add_f32 v26, v26, v30
    v_add_f32 v19, v19, v23
    v_add_f32 v27, v27, v31
    v_permlane16_swap_b32 v16, v18
    v_permlane16_swap_b32 v24, v26
    v_permlane16_swap_b32 v17, v19
    v_permlane16_swap_b32 v25, v27
    v_add_f32 v16, v16, v18
    v_add_f32 v24, v24, v26
    v_add_f32 v17, v17, v19
    v_add_f32 v25, v25, v27
    v_add_f32_dpp v16, v16, v16 row_ror:8 row_mask:0xf bank_mask:0xf
    v_add_f32_dpp v24, v24, v24 row_ror:8 row_mask:0xf bank_mask:0xf
    v_add_f32_dpp v17, v17, v17 row_ror:8 row_mask:0xf bank_mask:0xf
    v_add_f32_dpp v25, v25, v25 row_ror:8 row_mask:0xf bank_mask:0xf
    s_mov_b32 s28, 0xff00ff00
    s_mov_b32 s29, 0xff00ff00
    v_cndmask_b32 v6, v16, v17, s[28:29]
    v_cndmask_b32 v7, v24, v25, s[28:29]
    s_waitcnt lgkmcnt(0)
    s_mul_i32 s76, s76, 0x9E3779B1
    s_add_u32 s76, s76, 0x7F4A7C15
    v_mov_b32 v11, s76
    v_add_f32_dpp v6, v6, v6 quad_perm:[1,0,3,2] row_mask:0xf bank_mask:0xf
    v_add_f32_dpp v7, v7, v7 quad_perm:[1,0,3,2] row_mask:0xf bank_mask:0xf
    s_nop 0
    v_add_f32_dpp v6, v6, v6 quad_perm:[2,3,0,1] row_mask:0xf bank_mask:0xf
    v_add_f32_dpp v7, v7, v7 quad_perm:[2,3,0,1] row_mask:0xf bank_mask:0xf
    s_nop 0
    v_add_f32_dpp v6, v6, v6 row_half_mirror row_mask:0xf bank_mask:0xf
    v_add_f32_dpp v7, v7, v7 row_half_mirror row_mask:0xf bank_mask:0xf
    v_mul_f32 v12, 0x3b000000, v6
    v_mul_f32 v13, 0x3b000000, v7
    v_fma_f32 v13, -v12, v12, v13
    v_max_f32 v13, 0, v13
    v_cvt_pk_bf16_f32 v13, v13, v13
    v_and_b32 v13, 0xffff0000, v13
    v_add_f32 v13, 0x3727c5ac, v13
    v_cvt_pk_bf16_f32 v13, v13, v13
    v_and_b32 v13, 0xffff0000, v13
    v_sqrt_f32 v13, v13
    s_nop 0
    v_cvt_pk_bf16_f32 v10, -v12, v13
    s_mov_b32 exec_lo, 0x01010101
    s_mov_b32 exec_hi, 0x01010101
    buffer_store_dwordx2 v[10:11], v8, s[12:15], s36 offen sc1
    s_mov_b64 exec, -1
    s_setprio 0
    s_lshr_b32 s28, s39, 1
    s_lshl_b32 s30, s2, 1
    s_add_u32 s30, s30, s28
    v_lshlrev_b32 v112, 1, v0
    v_mov_b32 v113, 0
    s_lshl_b32 s29, s30, 8
    s_and_b32 s28, s20, 1
    s_lshl_b32 s28, s28, 7
    s_add_u32 s29, s29, s28
    s_lshl_b32 s30, s30, 1
    s_mov_b32 s18, 1024
    s_mov_b32 s19, 0x00020000
    v_mov_b32 v244, 0
    v_mov_b32 v245, 0
    v_mov_b32 v246, 0
    v_mov_b32 v247, 0
    v_mov_b32 v248, 0
    v_mov_b32 v249, 0
    v_mov_b32 v250, 0
    v_mov_b32 v251, 0
    s_waitcnt lgkmcnt(0)
    s_mov_b32 s16, s68
    s_mov_b32 s17, s69
    buffer_load_short_d16_hi v250, v113, s[16:19], s30 offen
    s_mov_b32 s16, s70
    s_mov_b32 s17, s71
    buffer_load_short_d16_hi v251, v113, s[16:19], s30 offen
    s_mov_b32 s18, 131072
    s_mov_b32 s16, s56
    s_mov_b32 s17, s57
    buffer_load_short_d16_hi v244, v112, s[16:19], s29 offen
    s_mov_b32 s16, s58
    s_mov_b32 s17, s59
    buffer_load_short_d16_hi v245, v112, s[16:19], s29 offen
    s_mov_b32 s16, s60
    s_mov_b32 s17, s61
    buffer_load_short_d16_hi v246, v112, s[16:19], s29 offen
    s_mov_b32 s16, s62
    s_mov_b32 s17, s63
    buffer_load_short_d16_hi v247, v112, s[16:19], s29 offen
    s_mov_b32 s16, s64
    s_mov_b32 s17, s65
    buffer_load_short_d16_hi v248, v112, s[16:19], s29 offen
    s_mov_b32 s16, s66
    s_mov_b32 s17, s67
    buffer_load_short_d16_hi v249, v112, s[16:19], s29 offen
    v_and_b32 v13, 0xffff0000, v10
    v_lshlrev_b32 v12, 16, v10
    v_rcp_f32 v5, v13
    s_nop 0
    v_fma_f32 v13, -v13, v5, 1.0
    v_fma_f32 v13, v13, v5, v5
    v_readlane_b32 s56, v12, 0
    v_readlane_b32 s64, v13, 0
    v_readlane_b32 s57, v12, 8
    v_readlane_b32 s65, v13, 8
    v_readlane_b32 s58, v12, 16
    v_readlane_b32 s66, v13, 16
    v_readlane_b32 s59, v12, 24
    v_readlane_b32 s67, v13, 24
    v_readlane_b32 s60, v12, 32
    v_readlane_b32 s68, v13, 32
    v_readlane_b32 s61, v12, 40
    v_readlane_b32 s69, v13, 40
    v_readlane_b32 s62, v12, 48
    v_readlane_b32 s70, v13, 48
    v_readlane_b32 s63, v12, 56
    v_readlane_b32 s71, v13, 56
    v_xor_b32 v5, s20, v2
    v_lshlrev_b32 v6, 10, v0
    v_lshl_add_u32 v6, v5, 4, v6
    v_dot2_f32_bf16 v112, v48, v14, s56
    v_dot2_f32_bf16 v113, v52, v14, s57
    v_dot2_f32_bf16 v114, v48, v15, s56
    v_dot2_f32_bf16 v115, v52, v15, s57
    v_dot2_f32_bf16 v116, v49, v14, s56
    v_dot2_f32_bf16 v117, v53, v14, s57
    v_dot2_f32_bf16 v118, v49, v15, s56
    v_dot2_f32_bf16 v119, v53, v15, s57
    v_dot2_f32_bf16 v120, v50, v14, s56
    v_dot2_f32_bf16 v121, v54, v14, s57
    v_dot2_f32_bf16 v122, v50, v15, s56
    v_dot2_f32_bf16 v123, v54, v15, s57
    v_dot2_f32_bf16 v124, v51, v14, s56
    v_dot2_f32_bf16 v125, v55, v14, s57
    v_dot2_f32_bf16 v126, v51, v15, s56
    v_dot2_f32_bf16 v127, v55, v15, s57
    v_pk_mul_f32 v[112:113], v[112:113], s[64:65]
    v_pk_mul_f32 v[114:115], v[114:115], s[64:65]
    v_pk_mul_f32 v[116:117], v[116:117], s[64:65]
    v_pk_mul_f32 v[118:119], v[118:119], s[64:65]
    v_pk_mul_f32 v[120:121], v[120:121], s[64:65]
    v_pk_mul_f32 v[122:123], v[122:123], s[64:65]
    v_pk_mul_f32 v[124:125], v[124:125], s[64:65]
    v_pk_mul_f32 v[126:127], v[126:127], s[64:65]
    v_cvt_pk_bf16_f32 v80, v112, v113
    v_cvt_pk_bf16_f32 v84, v114, v115
    v_cvt_pk_bf16_f32 v88, v116, v117
    v_cvt_pk_bf16_f32 v92, v118, v119
    v_cvt_pk_bf16_f32 v96, v120, v121
    v_cvt_pk_bf16_f32 v100, v122, v123
    v_cvt_pk_bf16_f32 v104, v124, v125
    v_cvt_pk_bf16_f32 v108, v126, v127
    v_dot2_f32_bf16 v112, v56, v14, s58
    v_dot2_f32_bf16 v113, v60, v14, s59
    v_dot2_f32_bf16 v114, v56, v15, s58
    v_dot2_f32_bf16 v115, v60, v15, s59
    v_dot2_f32_bf16 v116, v57, v14, s58
    v_dot2_f32_bf16 v117, v61, v14, s59
    v_dot2_f32_bf16 v118, v57, v15, s58
    v_dot2_f32_bf16 v119, v61, v15, s59
    v_dot2_f32_bf16 v120, v58, v14, s58
    v_dot2_f32_bf16 v121, v62, v14, s59
    v_dot2_f32_bf16 v122, v58, v15, s58
    v_dot2_f32_bf16 v123, v62, v15, s59
    v_dot2_f32_bf16 v124, v59, v14, s58
    v_dot2_f32_bf16 v125, v63, v14, s59
    v_dot2_f32_bf16 v126, v59, v15, s58
    v_dot2_f32_bf16 v127, v63, v15, s59
    v_pk_mul_f32 v[112:113], v[112:113], s[66:67]
    v_pk_mul_f32 v[114:115], v[114:115], s[66:67]
    v_pk_mul_f32 v[116:117], v[116:117], s[66:67]
    v_pk_mul_f32 v[118:119], v[118:119], s[66:67]
    v_pk_mul_f32 v[120:121], v[120:121], s[66:67]
    v_pk_mul_f32 v[122:123], v[122:123], s[66:67]
    v_pk_mul_f32 v[124:125], v[124:125], s[66:67]
    v_pk_mul_f32 v[126:127], v[126:127], s[66:67]
    v_cvt_pk_bf16_f32 v81, v112, v113
    v_cvt_pk_bf16_f32 v85, v114, v115
    v_cvt_pk_bf16_f32 v89, v116, v117
    v_cvt_pk_bf16_f32 v93, v118, v119
    v_cvt_pk_bf16_f32 v97, v120, v121
    v_cvt_pk_bf16_f32 v101, v122, v123
    v_cvt_pk_bf16_f32 v105, v124, v125
    v_cvt_pk_bf16_f32 v109, v126, v127
    v_dot2_f32_bf16 v112, v64, v14, s60
    v_dot2_f32_bf16 v113, v68, v14, s61
    v_dot2_f32_bf16 v114, v64, v15, s60
    v_dot2_f32_bf16 v115, v68, v15, s61
    v_dot2_f32_bf16 v116, v65, v14, s60
    v_dot2_f32_bf16 v117, v69, v14, s61
    v_dot2_f32_bf16 v118, v65, v15, s60
    v_dot2_f32_bf16 v119, v69, v15, s61
    v_dot2_f32_bf16 v120, v66, v14, s60
    v_dot2_f32_bf16 v121, v70, v14, s61
    v_dot2_f32_bf16 v122, v66, v15, s60
    v_dot2_f32_bf16 v123, v70, v15, s61
    v_dot2_f32_bf16 v124, v67, v14, s60
    v_dot2_f32_bf16 v125, v71, v14, s61
    v_dot2_f32_bf16 v126, v67, v15, s60
    v_dot2_f32_bf16 v127, v71, v15, s61
    v_pk_mul_f32 v[112:113], v[112:113], s[68:69]
    v_pk_mul_f32 v[114:115], v[114:115], s[68:69]
    v_pk_mul_f32 v[116:117], v[116:117], s[68:69]
    v_pk_mul_f32 v[118:119], v[118:119], s[68:69]
    v_pk_mul_f32 v[120:121], v[120:121], s[68:69]
    v_pk_mul_f32 v[122:123], v[122:123], s[68:69]
    v_pk_mul_f32 v[124:125], v[124:125], s[68:69]
    v_pk_mul_f32 v[126:127], v[126:127], s[68:69]
    v_cvt_pk_bf16_f32 v82, v112, v113
    v_cvt_pk_bf16_f32 v86, v114, v115
    v_cvt_pk_bf16_f32 v90, v116, v117
    v_cvt_pk_bf16_f32 v94, v118, v119
    v_cvt_pk_bf16_f32 v98, v120, v121
    v_cvt_pk_bf16_f32 v102, v122, v123
    v_cvt_pk_bf16_f32 v106, v124, v125
    v_cvt_pk_bf16_f32 v110, v126, v127
    v_dot2_f32_bf16 v112, v72, v14, s62
    v_dot2_f32_bf16 v113, v76, v14, s63
    v_dot2_f32_bf16 v114, v72, v15, s62
    v_dot2_f32_bf16 v115, v76, v15, s63
    v_dot2_f32_bf16 v116, v73, v14, s62
    v_dot2_f32_bf16 v117, v77, v14, s63
    v_dot2_f32_bf16 v118, v73, v15, s62
    v_dot2_f32_bf16 v119, v77, v15, s63
    v_dot2_f32_bf16 v120, v74, v14, s62
    v_dot2_f32_bf16 v121, v78, v14, s63
    v_dot2_f32_bf16 v122, v74, v15, s62
    v_dot2_f32_bf16 v123, v78, v15, s63
    v_dot2_f32_bf16 v124, v75, v14, s62
    v_dot2_f32_bf16 v125, v79, v14, s63
    v_dot2_f32_bf16 v126, v75, v15, s62
    v_dot2_f32_bf16 v127, v79, v15, s63
    v_pk_mul_f32 v[112:113], v[112:113], s[70:71]
    v_pk_mul_f32 v[114:115], v[114:115], s[70:71]
    v_pk_mul_f32 v[116:117], v[116:117], s[70:71]
    v_pk_mul_f32 v[118:119], v[118:119], s[70:71]
    v_pk_mul_f32 v[120:121], v[120:121], s[70:71]
    v_pk_mul_f32 v[122:123], v[122:123], s[70:71]
    v_pk_mul_f32 v[124:125], v[124:125], s[70:71]
    v_pk_mul_f32 v[126:127], v[126:127], s[70:71]
    v_cvt_pk_bf16_f32 v83, v112, v113
    v_cvt_pk_bf16_f32 v87, v114, v115
    v_cvt_pk_bf16_f32 v91, v116, v117
    v_cvt_pk_bf16_f32 v95, v118, v119
    v_cvt_pk_bf16_f32 v99, v120, v121
    v_cvt_pk_bf16_f32 v103, v122, v123
    v_cvt_pk_bf16_f32 v107, v124, v125
    v_cvt_pk_bf16_f32 v111, v126, v127
    s_mov_b32 s16, s48
    s_mov_b32 s17, s49
    s_mov_b32 s18, 1835008
    s_mov_b32 s19, 0x00020000
    v_lshrrev_b32 v28, 2, v0
    v_and_b32 v28, 4, v28
    v_and_b32 v29, 7, v0
    v_xor_b32 v28, v28, v29
    v_lshrrev_b32 v29, 3, v0
    v_lshlrev_b32 v23, 10, v29
    v_lshl_add_u32 v23, v28, 4, v23
    s_mul_i32 s72, s39, 458752
    s_lshl_b32 s75, s79, 7
    s_add_u32 s72, s72, s75
    s_lshl_b32 s73, s39, 13
    v_lshrrev_b32 v29, 5, v0
    v_bfe_u32 v28, v0, 2, 2
    v_lshl_add_u32 v24, v29, 2, v28
    v_lshlrev_b32 v24, 7, v24
    v_bfe_u32 v28, v0, 4, 1
    v_lshl_add_u32 v24, v28, 5, v24
    v_and_b32 v28, 3, v0
    v_lshl_add_u32 v24, v28, 3, v24
    v_bfe_u32 v28, v0, 3, 1
    v_lshl_add_u32 v24, v28, 6, v24
    v_add_u32 v24, s73, v24
    v_xor_b32 v25, 64, v24
    v_add_u32 v26, 0x10000, v24
    v_add_u32 v27, 0x10000, v25
    s_cmp_ge_u32 s20, 4
    s_cbranch_scc1 L_ln_nofill
L_ln_nofill:
    ds_write_b128 v6, v[80:83] offset:0
    ds_write_b128 v6, v[84:87] offset:128
    ds_write_b128 v6, v[88:91] offset:256
    ds_write_b128 v6, v[92:95] offset:384
    ds_write_b128 v6, v[96:99] offset:512
    ds_write_b128 v6, v[100:103] offset:640
    ds_write_b128 v6, v[104:107] offset:768
    ds_write_b128 v6, v[108:111] offset:896
    v_lshlrev_b32 v28, 2, v0
    v_mov_b32 v29, 0
    v_add_u32 v28, 157184, v28
    ds_write_b32 v28, v29
    s_lshl_b32 s28, s20, 13
    v_lshlrev_b32 v6, 7, v1
    v_lshl_add_u32 v6, v2, 4, v6
    v_add_u32 v6, s28, v6
    v_lshlrev_b32 v7, 7, v1
    v_lshl_add_u32 v7, v2, 4, v7
    s_lshl_b32 s26, s20, 13
    s_mul_i32 s28, s21, 67712
    s_add_u32 s26, s26, s28
    s_add_u32 s26, s26, 8388608
    s_lshl_b32 s33, s21, 2
    s_add_u32 s33, s33, 32768
    v_xor_b32 v8, 0, v6
    v_xor_b32 v9, 16, v6
    v_xor_b32 v10, 32, v6
    v_xor_b32 v11, 48, v6
    v_xor_b32 v12, 64, v6
    v_xor_b32 v13, 80, v6
    v_xor_b32 v14, 96, v6
    v_xor_b32 v15, 112, v6
    s_waitcnt lgkmcnt(0)
    s_barrier
    ds_read_b128 v[192:195], v8 offset:0
    ds_read_b128 v[196:199], v9 offset:1024
    ds_read_b128 v[200:203], v10 offset:2048
    ds_read_b128 v[204:207], v11 offset:3072
    ds_read_b128 v[208:211], v12 offset:4096
    ds_read_b128 v[212:215], v13 offset:5120
    ds_read_b128 v[216:219], v14 offset:6144
    ds_read_b128 v[220:223], v15 offset:7168
    s_waitcnt lgkmcnt(7)
    s_add_u32 s25, s26, 0
    buffer_store_dwordx4 v[192:195], v7, s[12:15], s25 offen sc1
    s_waitcnt lgkmcnt(6)
    s_add_u32 s25, s26, 1024
    buffer_store_dwordx4 v[196:199], v7, s[12:15], s25 offen sc1
    s_waitcnt lgkmcnt(5)
    s_add_u32 s25, s26, 2048
    buffer_store_dwordx4 v[200:203], v7, s[12:15], s25 offen sc1
    s_waitcnt lgkmcnt(4)
    s_add_u32 s25, s26, 3072
    buffer_store_dwordx4 v[204:207], v7, s[12:15], s25 offen sc1
    s_waitcnt lgkmcnt(3)
    s_add_u32 s25, s26, 4096
    buffer_store_dwordx4 v[208:211], v7, s[12:15], s25 offen sc1
    s_waitcnt lgkmcnt(2)
    s_add_u32 s25, s26, 5120
    buffer_store_dwordx4 v[212:215], v7, s[12:15], s25 offen sc1
    s_waitcnt lgkmcnt(1)
    s_add_u32 s25, s26, 6144
    buffer_store_dwordx4 v[216:219], v7, s[12:15], s25 offen sc1
    s_waitcnt lgkmcnt(0)
    s_add_u32 s25, s26, 7168
    buffer_store_dwordx4 v[220:223], v7, s[12:15], s25 offen sc1
    s_lshl_b32 s28, s20, 2
    s_add_u32 s28, s28, 157280
    v_mov_b32 v5, s28
    v_mov_b32 v6, 1
    s_cmp_lt_u32 s20, 4
    s_cbranch_scc1 L_ln_C
    s_lshl_b32 s28, s39, 13
    s_add_u32 s28, s28, 98304
    v_lshl_add_u32 v100, v0, 2, s28
    v_xor_b32 v101, 16, v100
    v_xor_b32 v102, 32, v100
    v_xor_b32 v103, 48, v100
    v_xor_b32 v104, 64, v100
    v_xor_b32 v105, 80, v100
    v_xor_b32 v106, 96, v100
    v_xor_b32 v107, 112, v100
    v_xor_b32 v108, 128, v100
    v_xor_b32 v109, 144, v100
    v_xor_b32 v110, 160, v100
    v_xor_b32 v111, 176, v100
    v_xor_b32 v112, 192, v100
    v_xor_b32 v113, 208, v100
    v_xor_b32 v114, 224, v100
    v_xor_b32 v115, 240, v100
    s_lshl_b32 s28, s39, 13
    s_add_u32 s28, s28, 98304
    v_and_b32 v28, 15, v0
    v_lshrrev_b32 v29, 5, v0
    v_xor_b32 v28, v28, v29
    v_and_b32 v29, 31, v0
    v_lshlrev_b32 v29, 8, v29
    v_lshl_add_u32 v116, v28, 4, v29
    v_add_u32 v116, s28, v116
    v_xor_b32 v117, 32, v116
    v_xor_b32 v118, 64, v116
    v_xor_b32 v119, 96, v116
    v_xor_b32 v120, 128, v116
    v_xor_b32 v121, 160, v116
    v_xor_b32 v122, 192, v116
    v_xor_b32 v123, 224, v116
    s_mov_b32 s33, 53248
    s_waitcnt vmcnt(8)
    v_mul_f32 v34, 0x3fb8aa00, v250
    v_mul_f32 v35, 0x36a407db, v250
    v_exp_f32 v34, v34
    s_nop 0
    v_fma_f32 v34, v34, v35, v34
    v_cvt_pk_bf16_f32 v34, v34, v34
    v_and_b32 v34, 0xffff0000, v34
    v_mul_f32 v144, v34, v244
    v_mul_f32 v145, v34, v245
    v_mul_f32 v246, v34, v246
    v_mul_f32 v247, v34, v247
    v_mul_f32 v144, 0x3fb8aa3b, v144
    v_mul_f32 v145, 0.15915494, v145
    v_mul_f32 v34, 0x41000000, v144
    v_mul_f32 v35, 0x41000000, v145
    v_exp_f32 v34, v34
    v_fract_f32 v35, v35
    v_cos_f32 v44, v35
    v_sin_f32 v45, v35
    v_mul_f32 v44, v44, v34
    v_mul_f32 v45, v45, v34
    v_pk_mul_f32 v[46:47], v[44:45], v[44:45] op_sel:[0,0] op_sel_hi:[0,1]
    v_pk_fma_f32 v[46:47], v[44:45], v[44:45], v[46:47] op_sel:[1,1,0] op_sel_hi:[1,0,1] neg_lo:[0,1,0]
    v_mov_b32 v95, 0x00003f80
    ds_write_b32 v100, v95
    v_cvt_pk_bf16_f32 v88, v44, v45
    ds_write_b32 v101, v88 offset:256
    v_cvt_pk_bf16_f32 v89, v46, v47
    ds_write_b32 v102, v89 offset:512
    v_pk_mul_f32 v[80:81], v[44:45], v[46:47] op_sel:[0,0] op_sel_hi:[0,1]
    v_pk_mul_f32 v[84:85], v[46:47], v[46:47] op_sel:[0,0] op_sel_hi:[0,1]
    v_pk_fma_f32 v[80:81], v[44:45], v[46:47], v[80:81] op_sel:[1,1,0] op_sel_hi:[1,0,1] neg_lo:[0,1,0]
    v_pk_fma_f32 v[84:85], v[46:47], v[46:47], v[84:85] op_sel:[1,1,0] op_sel_hi:[1,0,1] neg_lo:[0,1,0]
    v_cvt_pk_bf16_f32 v90, v80, v81
    v_cvt_pk_bf16_f32 v91, v84, v85
    ds_write_b32 v103, v90 offset:768
    ds_write_b32 v104, v91 offset:1024
    v_pk_mul_f32 v[82:83], v[80:81], v[46:47] op_sel:[0,0] op_sel_hi:[0,1]
    v_pk_mul_f32 v[86:87], v[84:85], v[46:47] op_sel:[0,0] op_sel_hi:[0,1]
    v_pk_fma_f32 v[82:83], v[80:81], v[46:47], v[82:83] op_sel:[1,1,0] op_sel_hi:[1,0,1] neg_lo:[0,1,0]
    v_pk_fma_f32 v[86:87], v[84:85], v[46:47], v[86:87] op_sel:[1,1,0] op_sel_hi:[1,0,1] neg_lo:[0,1,0]
    v_cvt_pk_bf16_f32 v92, v82, v83
    v_cvt_pk_bf16_f32 v93, v86, v87
    ds_write_b32 v105, v92 offset:1280
    ds_write_b32 v106, v93 offset:1536
    v_pk_mul_f32 v[80:81], v[82:83], v[46:47] op_sel:[0,0] op_sel_hi:[0,1]
    v_pk_mul_f32 v[84:85], v[86:87], v[46:47] op_sel:[0,0] op_sel_hi:[0,1]
    v_pk_fma_f32 v[80:81], v[82:83], v[46:47], v[80:81] op_sel:[1,1,0] op_sel_hi:[1,0,1] neg_lo:[0,1,0]
    v_pk_fma_f32 v[84:85], v[86:87], v[46:47], v[84:85] op_sel:[1,1,0] op_sel_hi:[1,0,1] neg_lo:[0,1,0]
    v_cvt_pk_bf16_f32 v94, v80, v81
    v_cvt_pk_bf16_f32 v95, v84, v85
    ds_write_b32 v107, v94 offset:1792
    ds_write_b32 v108, v95 offset:2048
    v_pk_mul_f32 v[82:83], v[80:81], v[46:47] op_sel:[0,0] op_sel_hi:[0,1]
    v_pk_mul_f32 v[86:87], v[84:85], v[46:47] op_sel:[0,0] op_sel_hi:[0,1]
    v_pk_fma_f32 v[82:83], v[80:81], v[46:47], v[82:83] op_sel:[1,1,0] op_sel_hi:[1,0,1] neg_lo:[0,1,0]
    v_pk_fma_f32 v[86:87], v[84:85], v[46:47], v[86:87] op_sel:[1,1,0] op_sel_hi:[1,0,1] neg_lo:[0,1,0]
    v_cvt_pk_bf16_f32 v88, v82, v83
    v_cvt_pk_bf16_f32 v89, v86, v87
    ds_write_b32 v109, v88 offset:2304
    ds_write_b32 v110, v89 offset:2560
    v_pk_mul_f32 v[80:81], v[82:83], v[46:47] op_sel:[0,0] op_sel_hi:[0,1]
    v_pk_mul_f32 v[84:85], v[86:87], v[46:47] op_sel:[0,0] op_sel_hi:[0,1]
    v_pk_fma_f32 v[80:81], v[82:83], v[46:47], v[80:81] op_sel:[1,1,0] op_sel_hi:[1,0,1] neg_lo:[0,1,0]
    v_pk_fma_f32 v[84:85], v[86:87], v[46:47], v[84:85] op_sel:[1,1,0] op_sel_hi:[1,0,1] neg_lo:[0,1,0]
    v_cvt_pk_bf16_f32 v90, v80, v81
    v_cvt_pk_bf16_f32 v91, v84, v85
    ds_write_b32 v111, v90 offset:2816
    ds_write_b32 v112, v91 offset:3072
    v_pk_mul_f32 v[82:83], v[80:81], v[46:47] op_sel:[0,0] op_sel_hi:[0,1]
    v_pk_mul_f32 v[86:87], v[84:85], v[46:47] op_sel:[0,0] op_sel_hi:[0,1]
    v_pk_fma_f32 v[82:83], v[80:81], v[46:47], v[82:83] op_sel:[1,1,0] op_sel_hi:[1,0,1] neg_lo:[0,1,0]
    v_pk_fma_f32 v[86:87], v[84:85], v[46:47], v[86:87] op_sel:[1,1,0] op_sel_hi:[1,0,1] neg_lo:[0,1,0]
    v_cvt_pk_bf16_f32 v92, v82, v83
    v_cvt_pk_bf16_f32 v93, v86, v87
    ds_write_b32 v113, v92 offset:3328
    s_waitcnt vmcnt(0)
    ds_write_b32 v5, v6
    v_add_u32 v5, 64, v5
    ds_write_b32 v114, v93 offset:3584
    v_pk_mul_f32 v[80:81], v[82:83], v[46:47] op_sel:[0,0] op_sel_hi:[0,1]
    v_pk_mul_f32 v[84:85], v[86:87], v[46:47] op_sel:[0,0] op_sel_hi:[0,1]
    v_pk_fma_f32 v[80:81], v[82:83], v[46:47], v[80:81] op_sel:[1,1,0] op_sel_hi:[1,0,1] neg_lo:[0,1,0]
    v_pk_fma_f32 v[84:85], v[86:87], v[46:47], v[84:85] op_sel:[1,1,0] op_sel_hi:[1,0,1] neg_lo:[0,1,0]
    v_cvt_pk_bf16_f32 v94, v80, v81
    v_cvt_pk_bf16_f32 v95, v84, v85
    ds_write_b32 v115, v94 offset:3840
    ds_write_b32 v100, v95 offset:4096
    v_pk_mul_f32 v[82:83], v[80:81], v[46:47] op_sel:[0,0] op_sel_hi:[0,1]
    v_pk_mul_f32 v[86:87], v[84:85], v[46:47] op_sel:[0,0] op_sel_hi:[0,1]
    v_pk_fma_f32 v[82:83], v[80:81], v[46:47], v[82:83] op_sel:[1,1,0] op_sel_hi:[1,0,1] neg_lo:[0,1,0]
    v_pk_fma_f32 v[86:87], v[84:85], v[46:47], v[86:87] op_sel:[1,1,0] op_sel_hi:[1,0,1] neg_lo:[0,1,0]
    v_cvt_pk_bf16_f32 v88, v82, v83
    v_cvt_pk_bf16_f32 v89, v86, v87
    ds_write_b32 v101, v88 offset:4352
    ds_write_b32 v102, v89 offset:4608
    v_pk_mul_f32 v[80:81], v[82:83], v[46:47] op_sel:[0,0] op_sel_hi:[0,1]
    v_pk_mul_f32 v[84:85], v[86:87], v[46:47] op_sel:[0,0] op_sel_hi:[0,1]
    v_pk_fma_f32 v[80:81], v[82:83], v[46:47], v[80:81] op_sel:[1,1,0] op_sel_hi:[1,0,1] neg_lo:[0,1,0]
    v_pk_fma_f32 v[84:85], v[86:87], v[46:47], v[84:85] op_sel:[1,1,0] op_sel_hi:[1,0,1] neg_lo:[0,1,0]
    v_cvt_pk_bf16_f32 v90, v80, v81
    v_cvt_pk_bf16_f32 v91, v84, v85
    ds_write_b32 v103, v90 offset:4864
    ds_write_b32 v104, v91 offset:5120
    v_pk_mul_f32 v[82:83], v[80:81], v[46:47] op_sel:[0,0] op_sel_hi:[0,1]
    v_pk_mul_f32 v[86:87], v[84:85], v[46:47] op_sel:[0,0] op_sel_hi:[0,1]
    v_pk_fma_f32 v[82:83], v[80:81], v[46:47], v[82:83] op_sel:[1,1,0] op_sel_hi:[1,0,1] neg_lo:[0,1,0]
    v_pk_fma_f32 v[86:87], v[84:85], v[46:47], v[86:87] op_sel:[1,1,0] op_sel_hi:[1,0,1] neg_lo:[0,1,0]
    v_cvt_pk_bf16_f32 v92, v82, v83
    v_cvt_pk_bf16_f32 v93, v86, v87
    ds_write_b32 v105, v92 offset:5376
    ds_write_b32 v106, v93 offset:5632
    v_pk_mul_f32 v[80:81], v[82:83], v[46:47] op_sel:[0,0] op_sel_hi:[0,1]
    v_pk_mul_f32 v[84:85], v[86:87], v[46:47] op_sel:[0,0] op_sel_hi:[0,1]
    v_pk_fma_f32 v[80:81], v[82:83], v[46:47], v[80:81] op_sel:[1,1,0] op_sel_hi:[1,0,1] neg_lo:[0,1,0]
    v_pk_fma_f32 v[84:85], v[86:87], v[46:47], v[84:85] op_sel:[1,1,0] op_sel_hi:[1,0,1] neg_lo:[0,1,0]
    v_cvt_pk_bf16_f32 v94, v80, v81
    v_cvt_pk_bf16_f32 v95, v84, v85
    ds_write_b32 v107, v94 offset:5888
    ds_write_b32 v108, v95 offset:6144
    v_pk_mul_f32 v[82:83], v[80:81], v[46:47] op_sel:[0,0] op_sel_hi:[0,1]
    v_pk_mul_f32 v[86:87], v[84:85], v[46:47] op_sel:[0,0] op_sel_hi:[0,1]
    v_pk_fma_f32 v[82:83], v[80:81], v[46:47], v[82:83] op_sel:[1,1,0] op_sel_hi:[1,0,1] neg_lo:[0,1,0]
    v_pk_fma_f32 v[86:87], v[84:85], v[46:47], v[86:87] op_sel:[1,1,0] op_sel_hi:[1,0,1] neg_lo:[0,1,0]
    v_cvt_pk_bf16_f32 v88, v82, v83
    v_cvt_pk_bf16_f32 v89, v86, v87
    ds_write_b32 v109, v88 offset:6400
    ds_write_b32 v110, v89 offset:6656
    v_pk_mul_f32 v[80:81], v[82:83], v[46:47] op_sel:[0,0] op_sel_hi:[0,1]
    v_pk_mul_f32 v[84:85], v[86:87], v[46:47] op_sel:[0,0] op_sel_hi:[0,1]
    v_pk_fma_f32 v[80:81], v[82:83], v[46:47], v[80:81] op_sel:[1,1,0] op_sel_hi:[1,0,1] neg_lo:[0,1,0]
    v_pk_fma_f32 v[84:85], v[86:87], v[46:47], v[84:85] op_sel:[1,1,0] op_sel_hi:[1,0,1] neg_lo:[0,1,0]
    v_cvt_pk_bf16_f32 v90, v80, v81
    v_cvt_pk_bf16_f32 v91, v84, v85
    ds_write_b32 v111, v90 offset:6912
    ds_write_b32 v112, v91 offset:7168
    v_pk_mul_f32 v[82:83], v[80:81], v[46:47] op_sel:[0,0] op_sel_hi:[0,1]
    v_pk_mul_f32 v[86:87], v[84:85], v[46:47] op_sel:[0,0] op_sel_hi:[0,1]
    v_pk_fma_f32 v[82:83], v[80:81], v[46:47], v[82:83] op_sel:[1,1,0] op_sel_hi:[1,0,1] neg_lo:[0,1,0]
    v_pk_fma_f32 v[86:87], v[84:85], v[46:47], v[86:87] op_sel:[1,1,0] op_sel_hi:[1,0,1] neg_lo:[0,1,0]
    v_cvt_pk_bf16_f32 v92, v82, v83
    v_cvt_pk_bf16_f32 v93, v86, v87
    ds_write_b32 v113, v92 offset:7424
    ds_write_b32 v114, v93 offset:7680
    v_pk_mul_f32 v[80:81], v[82:83], v[46:47] op_sel:[0,0] op_sel_hi:[0,1]
    v_pk_fma_f32 v[80:81], v[82:83], v[46:47], v[80:81] op_sel:[1,1,0] op_sel_hi:[1,0,1] neg_lo:[0,1,0]
    v_cvt_pk_bf16_f32 v94, v80, v81
    ds_write_b32 v115, v94 offset:7936
    ds_read_b128 v[160:163], v116
    ds_read_b128 v[164:167], v117
    ds_read_b128 v[168:171], v118
    ds_read_b128 v[172:175], v119
    ds_read_b128 v[176:179], v120
    ds_read_b128 v[180:183], v121
    ds_read_b128 v[184:187], v122
    ds_read_b128 v[188:191], v123
    s_branch L_ln_H2
L_ln_C:
    v_lshrrev_b32 v114, 3, v0
    v_and_b32 v115, 7, v0
    v_lshlrev_b32 v114, 13, v114
    v_lshl_add_u32 v114, v115, 4, v114
    s_lshr_b32 s28, s39, 1
    s_lshl_b32 s31, s2, 1
    s_add_u32 s31, s31, s28
    s_lshr_b32 s29, s31, 6
    s_lshl_b32 s29, s29, 18
    s_and_b32 s28, s31, 63
    s_lshl_b32 s28, s28, 7
    s_add_u32 s29, s29, s28
    s_add_u32 s29, s29, 12582912
    s_and_b32 s30, s39, 1
    s_lshl_b32 s30, s30, 17
    s_add_u32 s30, s30, s29
    s_add_u32 s31, s30, 65536
    v_mov_b32 v116, -1
    v_mov_b32 v117, -1
    v_mov_b32 v118, -1
    v_mov_b32 v119, -1
    buffer_store_dwordx4 v[116:119], v114, s[12:15], s30 offen sc1
    buffer_store_dwordx4 v[116:119], v114, s[12:15], s31 offen sc1
    v_mov_b32 v30, 157280
    s_waitcnt vmcnt(0)
    ds_write_b32 v5, v6
    s_lshr_b32 s28, s39, 1
    s_lshl_b32 s29, s2, 1
    s_add_u32 s28, s28, s29
    s_and_b32 s29, s39, 1
    s_lshl_b32 s29, s29, 9
    s_add_u32 s28, s28, s29
    s_lshl_b32 s28, s28, 2
    s_add_u32 s28, s28, 262144
    v_mov_b32 v34, 0
    v_mov_b32 v35, s76
    s_mov_b64 exec, 1
    buffer_store_dword v35, v34, s[12:15], s28 offen sc1
    s_mov_b64 exec, -1
L_ln_cs:
    ds_read_b128 v[36:39], v30
    ds_read_b128 v[40:43], v30 offset:16
    s_waitcnt lgkmcnt(0)
    v_and_b32 v36, v36, v37
    v_and_b32 v38, v38, v39
    v_and_b32 v40, v40, v41
    v_and_b32 v42, v42, v43
    v_and_b32 v36, v36, v38
    v_and_b32 v40, v40, v42
    v_and_b32 v36, v36, v40
    s_nop 0
    v_readfirstlane_b32 s28, v36
    s_nop 0
    s_cmp_eq_u32 s28, 1
    s_cbranch_scc0 L_ln_cs
    s_cmp_lg_u32 s20, 0
    s_cbranch_scc1 L_pub_skipl
    v_mov_b32 v32, 0
    v_mov_b32 v33, s76
    s_mov_b64 exec, 1
    buffer_store_dword v33, v32, s[12:15], s33 offen sc1
    s_mov_b64 exec, -1
L_pub_skipl:
    s_mov_b32 s33, 53248
    v_lshrrev_b32 v28, 3, v0
    v_and_b32 v29, 7, v0
    v_lshlrev_b32 v28, 10, v28
    v_lshlrev_b32 v29, 4, v29
    v_add_u32 v28, v28, v29
    s_lshl_b32 s29, s78, 6
    s_lshl_b32 s28, s20, 3
    s_add_u32 s29, s29, s28
    s_lshl_b32 s29, s29, 10
    s_lshl_b32 s30, s79, 7
    s_add_u32 s29, s29, s30
    s_mov_b32 s8, s50
    s_mov_b32 s9, s51
    s_mov_b32 s10, 1024
    s_mov_b32 s11, 0x00020000
    buffer_load_dwordx4 v[4:7], v28, s[4:7], s29 offen
    buffer_load_dwordx4 v[8:11], v29, s[8:11], s30 offen
    s_add_u32 s31, s74, 0
    s_sub_u32 s75, s31, 28672
    s_min_u32 s31, s31, s75
    s_add_u32 m0, s73, 0
    s_lshl4_add_u32 s31, s31, s72
    buffer_load_dwordx4 v23, s[16:19], s31 offen lds
    s_add_u32 m0, s73, 1024
    s_add_u32 s31, s31, 8192
    buffer_load_dwordx4 v23, s[16:19], s31 offen lds
    s_add_u32 s31, s74, 1024
    s_sub_u32 s75, s31, 28672
    s_min_u32 s31, s31, s75
    s_add_u32 m0, s73, 2048
    s_lshl4_add_u32 s31, s31, s72
    buffer_load_dwordx4 v23, s[16:19], s31 offen lds
    s_add_u32 m0, s73, 3072
    s_add_u32 s31, s31, 8192
    buffer_load_dwordx4 v23, s[16:19], s31 offen lds
    s_add_u32 s31, s74, 2048
    s_sub_u32 s75, s31, 28672
    s_min_u32 s31, s31, s75
    s_add_u32 m0, s73, 4096
    s_lshl4_add_u32 s31, s31, s72
    buffer_load_dwordx4 v23, s[16:19], s31 offen lds
    s_add_u32 m0, s73, 5120
    s_add_u32 s31, s31, 8192
    buffer_load_dwordx4 v23, s[16:19], s31 offen lds
    s_add_u32 s31, s74, 3072
    s_sub_u32 s75, s31, 28672
    s_min_u32 s31, s31, s75
    s_add_u32 m0, s73, 6144
    s_lshl4_add_u32 s31, s31, s72
    buffer_load_dwordx4 v23, s[16:19], s31 offen lds
    s_add_u32 m0, s73, 7168
    s_add_u32 s31, s31, 8192
    buffer_load_dwordx4 v23, s[16:19], s31 offen lds
    s_add_u32 s31, s74, 4096
    s_sub_u32 s75, s31, 28672
    s_min_u32 s31, s31, s75
    s_add_u32 m0, s73, 32768
    s_lshl4_add_u32 s31, s31, s72
    buffer_load_dwordx4 v23, s[16:19], s31 offen lds
    s_add_u32 m0, s73, 33792
    s_add_u32 s31, s31, 8192
    buffer_load_dwordx4 v23, s[16:19], s31 offen lds
    s_add_u32 s31, s74, 5120
    s_sub_u32 s75, s31, 28672
    s_min_u32 s31, s31, s75
    s_add_u32 m0, s73, 34816
    s_lshl4_add_u32 s31, s31, s72
    buffer_load_dwordx4 v23, s[16:19], s31 offen lds
    s_add_u32 m0, s73, 35840
    s_add_u32 s31, s31, 8192
    buffer_load_dwordx4 v23, s[16:19], s31 offen lds
    s_add_u32 s31, s74, 6144
    s_sub_u32 s75, s31, 28672
    s_min_u32 s31, s31, s75
    s_add_u32 m0, s73, 36864
    s_lshl4_add_u32 s31, s31, s72
    buffer_load_dwordx4 v23, s[16:19], s31 offen lds
    s_add_u32 m0, s73, 37888
    s_add_u32 s31, s31, 8192
    buffer_load_dwordx4 v23, s[16:19], s31 offen lds
    s_add_u32 s31, s74, 7168
    s_sub_u32 s75, s31, 28672
    s_min_u32 s31, s31, s75
    s_add_u32 m0, s73, 38912
    s_lshl4_add_u32 s31, s31, s72
    buffer_load_dwordx4 v23, s[16:19], s31 offen lds
    s_add_u32 m0, s73, 39936
    s_add_u32 s31, s31, 8192
    buffer_load_dwordx4 v23, s[16:19], s31 offen lds
    s_add_u32 s31, s74, 8192
    s_sub_u32 s75, s31, 28672
    s_min_u32 s31, s31, s75
    s_add_u32 m0, s73, 65536
    s_lshl4_add_u32 s31, s31, s72
    buffer_load_dwordx4 v23, s[16:19], s31 offen lds
    s_add_u32 m0, s73, 66560
    s_add_u32 s31, s31, 8192
    buffer_load_dwordx4 v23, s[16:19], s31 offen lds
    s_add_u32 s31, s74, 9216
    s_sub_u32 s75, s31, 28672
    s_min_u32 s31, s31, s75
    s_add_u32 m0, s73, 67584
    s_lshl4_add_u32 s31, s31, s72
    buffer_load_dwordx4 v23, s[16:19], s31 offen lds
    s_add_u32 m0, s73, 68608
    s_add_u32 s31, s31, 8192
    buffer_load_dwordx4 v23, s[16:19], s31 offen lds
    s_add_u32 s31, s74, 10240
    s_sub_u32 s75, s31, 28672
    s_min_u32 s31, s31, s75
    s_add_u32 m0, s73, 69632
    s_lshl4_add_u32 s31, s31, s72
    buffer_load_dwordx4 v23, s[16:19], s31 offen lds
    s_add_u32 m0, s73, 70656
    s_add_u32 s31, s31, 8192
    buffer_load_dwordx4 v23, s[16:19], s31 offen lds
    s_add_u32 s31, s74, 11264
    s_sub_u32 s75, s31, 28672
    s_min_u32 s31, s31, s75
    s_add_u32 m0, s73, 71680
    s_lshl4_add_u32 s31, s31, s72
    buffer_load_dwordx4 v23, s[16:19], s31 offen lds
    s_add_u32 m0, s73, 72704
    s_add_u32 s31, s31, 8192
    buffer_load_dwordx4 v23, s[16:19], s31 offen lds
    s_waitcnt vmcnt(0)
    ds_read_b64_tr_b16 v[160:161], v24 offset:0
    ds_read_b64_tr_b16 v[162:163], v24 offset:1024
    ds_read_b64_tr_b16 v[164:165], v25 offset:0
    ds_read_b64_tr_b16 v[166:167], v25 offset:1024
    ds_read_b64_tr_b16 v[168:169], v24 offset:2048
    ds_read_b64_tr_b16 v[170:171], v24 offset:3072
    ds_read_b64_tr_b16 v[172:173], v25 offset:2048
    ds_read_b64_tr_b16 v[174:175], v25 offset:3072
    ds_read_b64_tr_b16 v[176:177], v24 offset:4096
    ds_read_b64_tr_b16 v[178:179], v24 offset:5120
    ds_read_b64_tr_b16 v[180:181], v25 offset:4096
    ds_read_b64_tr_b16 v[182:183], v25 offset:5120
    ds_read_b64_tr_b16 v[184:185], v24 offset:6144
    ds_read_b64_tr_b16 v[186:187], v24 offset:7168
    ds_read_b64_tr_b16 v[188:189], v25 offset:6144
    ds_read_b64_tr_b16 v[190:191], v25 offset:7168
    ds_read_b64_tr_b16 v[192:193], v24 offset:32768
    ds_read_b64_tr_b16 v[194:195], v24 offset:33792
    ds_read_b64_tr_b16 v[196:197], v25 offset:32768
    ds_read_b64_tr_b16 v[198:199], v25 offset:33792
    ds_read_b64_tr_b16 v[200:201], v24 offset:34816
    ds_read_b64_tr_b16 v[202:203], v24 offset:35840
    ds_read_b64_tr_b16 v[204:205], v25 offset:34816
    ds_read_b64_tr_b16 v[206:207], v25 offset:35840
    ds_read_b64_tr_b16 v[208:209], v24 offset:36864
    ds_read_b64_tr_b16 v[210:211], v24 offset:37888
    ds_read_b64_tr_b16 v[212:213], v25 offset:36864
    ds_read_b64_tr_b16 v[214:215], v25 offset:37888
    ds_read_b64_tr_b16 v[216:217], v24 offset:38912
    ds_read_b64_tr_b16 v[218:219], v24 offset:39936
    ds_read_b64_tr_b16 v[220:221], v25 offset:38912
    ds_read_b64_tr_b16 v[222:223], v25 offset:39936
    ds_read_b64_tr_b16 v[224:225], v26 offset:0
    ds_read_b64_tr_b16 v[226:227], v26 offset:1024
    ds_read_b64_tr_b16 v[228:229], v27 offset:0
    ds_read_b64_tr_b16 v[230:231], v27 offset:1024
    ds_read_b64_tr_b16 v[232:233], v26 offset:2048
    ds_read_b64_tr_b16 v[234:235], v26 offset:3072
    ds_read_b64_tr_b16 v[236:237], v27 offset:2048
    ds_read_b64_tr_b16 v[238:239], v27 offset:3072
    ds_read_b64_tr_b16 v[240:241], v26 offset:4096
    ds_read_b64_tr_b16 v[242:243], v26 offset:5120
    ds_read_b64_tr_b16 v[244:245], v27 offset:4096
    ds_read_b64_tr_b16 v[246:247], v27 offset:5120
    ds_read_b64_tr_b16 v[248:249], v26 offset:6144
    ds_read_b64_tr_b16 v[250:251], v26 offset:7168
    ds_read_b64_tr_b16 v[252:253], v27 offset:6144
    ds_read_b64_tr_b16 v[254:255], v27 offset:7168
    v_mov_b32 v28, 157200
L_ln_cw:
    ds_read_b128 v[32:35], v28
    s_waitcnt lgkmcnt(0)
    v_and_b32 v32, v32, v33
    v_and_b32 v34, v34, v35
    v_and_b32 v32, v32, v34
    s_nop 0
    v_readfirstlane_b32 s28, v32
    s_nop 0
    s_cmp_eq_u32 s28, 1
    s_cbranch_scc0 L_ln_cw
    s_add_u32 s31, s74, 12288
    s_sub_u32 s75, s31, 28672
    s_min_u32 s31, s31, s75
    s_add_u32 m0, s73, 0
    s_lshl4_add_u32 s31, s31, s72
    buffer_load_dwordx4 v23, s[16:19], s31 offen lds
    s_add_u32 m0, s73, 1024
    s_add_u32 s31, s31, 8192
    buffer_load_dwordx4 v23, s[16:19], s31 offen lds
    s_add_u32 s31, s74, 13312
    s_sub_u32 s75, s31, 28672
    s_min_u32 s31, s31, s75
    s_add_u32 m0, s73, 2048
    s_lshl4_add_u32 s31, s31, s72
    buffer_load_dwordx4 v23, s[16:19], s31 offen lds
    s_add_u32 m0, s73, 3072
    s_add_u32 s31, s31, 8192
    buffer_load_dwordx4 v23, s[16:19], s31 offen lds
    s_add_u32 s31, s74, 14336
    s_sub_u32 s75, s31, 28672
    s_min_u32 s31, s31, s75
    s_add_u32 m0, s73, 4096
    s_lshl4_add_u32 s31, s31, s72
    buffer_load_dwordx4 v23, s[16:19], s31 offen lds
    s_add_u32 m0, s73, 5120
    s_add_u32 s31, s31, 8192
    buffer_load_dwordx4 v23, s[16:19], s31 offen lds
    s_add_u32 s31, s74, 15360
    s_sub_u32 s75, s31, 28672
    s_min_u32 s31, s31, s75
    s_add_u32 m0, s73, 6144
    s_lshl4_add_u32 s31, s31, s72
    buffer_load_dwordx4 v23, s[16:19], s31 offen lds
    s_add_u32 m0, s73, 7168
    s_add_u32 s31, s31, 8192
    buffer_load_dwordx4 v23, s[16:19], s31 offen lds
    s_add_u32 s31, s74, 16384
    s_sub_u32 s75, s31, 28672
    s_min_u32 s31, s31, s75
    s_add_u32 m0, s73, 32768
    s_lshl4_add_u32 s31, s31, s72
    buffer_load_dwordx4 v23, s[16:19], s31 offen lds
    s_add_u32 m0, s73, 33792
    s_add_u32 s31, s31, 8192
    buffer_load_dwordx4 v23, s[16:19], s31 offen lds
    s_add_u32 s31, s74, 17408
    s_sub_u32 s75, s31, 28672
    s_min_u32 s31, s31, s75
    s_add_u32 m0, s73, 34816
    s_lshl4_add_u32 s31, s31, s72
    buffer_load_dwordx4 v23, s[16:19], s31 offen lds
    s_add_u32 m0, s73, 35840
    s_add_u32 s31, s31, 8192
    buffer_load_dwordx4 v23, s[16:19], s31 offen lds
    s_add_u32 s31, s74, 18432
    s_sub_u32 s75, s31, 28672
    s_min_u32 s31, s31, s75
    s_add_u32 m0, s73, 36864
    s_lshl4_add_u32 s31, s31, s72
    buffer_load_dwordx4 v23, s[16:19], s31 offen lds
    s_add_u32 m0, s73, 37888
    s_add_u32 s31, s31, 8192
    buffer_load_dwordx4 v23, s[16:19], s31 offen lds
    s_add_u32 s31, s74, 19456
    s_sub_u32 s75, s31, 28672
    s_min_u32 s31, s31, s75
    s_add_u32 m0, s73, 38912
    s_lshl4_add_u32 s31, s31, s72
    buffer_load_dwordx4 v23, s[16:19], s31 offen lds
    s_add_u32 m0, s73, 39936
    s_add_u32 s31, s31, 8192
    buffer_load_dwordx4 v23, s[16:19], s31 offen lds
    s_add_u32 s31, s74, 20480
    s_sub_u32 s75, s31, 28672
    s_min_u32 s31, s31, s75
    s_add_u32 m0, s73, 65536
    s_lshl4_add_u32 s31, s31, s72
    buffer_load_dwordx4 v23, s[16:19], s31 offen lds
    s_add_u32 m0, s73, 66560
    s_add_u32 s31, s31, 8192
    buffer_load_dwordx4 v23, s[16:19], s31 offen lds
    s_add_u32 s31, s74, 21504
    s_sub_u32 s75, s31, 28672
    s_min_u32 s31, s31, s75
    s_add_u32 m0, s73, 67584
    s_lshl4_add_u32 s31, s31, s72
    buffer_load_dwordx4 v23, s[16:19], s31 offen lds
    s_add_u32 m0, s73, 68608
    s_add_u32 s31, s31, 8192
    buffer_load_dwordx4 v23, s[16:19], s31 offen lds
    s_add_u32 s31, s74, 22528
    s_sub_u32 s75, s31, 28672
    s_min_u32 s31, s31, s75
    s_add_u32 m0, s73, 69632
    s_lshl4_add_u32 s31, s31, s72
    buffer_load_dwordx4 v23, s[16:19], s31 offen lds
    s_add_u32 m0, s73, 70656
    s_add_u32 s31, s31, 8192
    buffer_load_dwordx4 v23, s[16:19], s31 offen lds
    s_add_u32 s31, s74, 23552
    s_sub_u32 s75, s31, 28672
    s_min_u32 s31, s31, s75
    s_add_u32 m0, s73, 71680
    s_lshl4_add_u32 s31, s31, s72
    buffer_load_dwordx4 v23, s[16:19], s31 offen lds
    s_add_u32 m0, s73, 72704
    s_add_u32 s31, s31, 8192
    buffer_load_dwordx4 v23, s[16:19], s31 offen lds
    s_lshl_b32 s28, s20, 8
    s_add_u32 s28, s28, s2
    s_cmp_lg_u32 s28, 255
    s_cbranch_scc1 L_nobump
    v_lshlrev_b32 v28, 3, v0
    s_mov_b32 s30, 0
L_bump_poll:
    s_mov_b32 s28, 262144
    buffer_load_dword v32, v28, s[12:15], s28 offen sc1
    s_mov_b32 s28, 262656
    buffer_load_dword v33, v28, s[12:15], s28 offen sc1
    s_mov_b32 s28, 263168
    buffer_load_dword v34, v28, s[12:15], s28 offen sc1
    s_mov_b32 s28, 263680
    buffer_load_dword v35, v28, s[12:15], s28 offen sc1
    s_add_u32 s30, s30, 1
    s_waitcnt vmcnt(0)
    v_xor_b32 v32, s76, v32
    v_xor_b32 v33, s76, v33
    v_xor_b32 v34, s76, v34
    v_xor_b32 v35, s76, v35
    v_or3_b32 v32, v32, v33, v34
    v_or_b32 v32, v32, v35
    v_cmp_ne_u32 vcc, 0, v32
    s_cmp_gt_u32 s30, 262144
    s_cbranch_scc1 L_bump_go
    s_cbranch_vccnz L_bump_poll
L_bump_go:
    s_mov_b32 s28, 49152
    v_mov_b32 v28, 0
    v_mov_b32 v29, s76
    s_mov_b64 exec, 1
    buffer_store_dword v29, v28, s[12:15], s28 offen sc1
    s_mov_b64 exec, -1
L_nobump:
    s_mov_b32 s37, 1
    s_branch L_gemm2
L_gemm2:
    s_nop 1
    s_setprio 2
    s_mov_b32 s22, s33
    v_lshrrev_b32 v1, 3, v0
    v_and_b32 v2, 7, v0
    v_lshlrev_b32 v12, 10, v1
    v_lshl_add_u32 v12, v2, 4, v12
    v_lshlrev_b32 v3, 4, v2
    s_lshl_b32 s33, s78, 6
    s_lshl_b32 s28, s20, 3
    s_add_u32 s33, s33, s28
    s_lshl_b32 s33, s33, 10
    s_lshl_b32 s34, s79, 7
    s_add_u32 s33, s33, s34
    v_mov_b32 v14, v24
    v_mov_b32 v15, v25
    v_mov_b32 v16, v26
    v_mov_b32 v17, v27
    v_lshlrev_b32 v13, 4, v0
    v_lshrrev_b32 v22, 5, v0
    v_xor_b32 v22, v22, v2
    v_and_b32 v18, 31, v0
    v_lshlrev_b32 v18, 8, v18
    v_lshl_add_u32 v18, v22, 4, v18
    v_add_u32 v18, s73, v18
    v_xor_b32 v19, 32, v18
    v_xor_b32 v20, 64, v18
    v_xor_b32 v21, 96, v18
    s_mul_i32 s24, s78, 229376
    s_mul_i32 s28, s20, 28672
    s_add_u32 s24, s24, s28
    s_add_u32 s24, s24, 1048576
    s_add_u32 s25, s24, 114688
    s_mul_i32 s26, s20, 1
    s_lshl_b32 s28, s78, 2
    s_add_u32 s26, s26, s28
    s_lshl_b32 s26, s26, 7
    s_add_u32 s26, s26, 131072
    v_min_u32 v22, 6, v2
    v_lshlrev_b32 v22, 2, v22
    s_lshl_b32 s28, s20, 2
    s_add_u32 s28, s28, 157200
    v_mov_b32 v28, s28
    v_mov_b32 v29, 1
    ds_write_b32 v28, v29 offset:16
    s_mov_b32 s30, 0
    s_cmp_eq_u32 s37, 1
    s_cbranch_scc1 L_g2_poll
    s_waitcnt vmcnt(0)
    v_mov_b32 v24, 0
    v_mov_b32 v25, s76
    s_mov_b64 exec, 1
    buffer_store_dword v25, v24, s[12:15], s22 offen sc1
    s_mov_b64 exec, -1
L_g2_rr:
    ds_read_b32 v29, v28
    s_waitcnt lgkmcnt(0)
    v_readfirstlane_b32 s28, v29
    s_nop 0
    s_cmp_eq_u32 s28, 1
    s_cbranch_scc0 L_g2_rr
    ds_read_b64_tr_b16 v[160:161], v14 offset:0
    ds_read_b64_tr_b16 v[162:163], v14 offset:1024
    ds_read_b64_tr_b16 v[164:165], v15 offset:0
    ds_read_b64_tr_b16 v[166:167], v15 offset:1024
    ds_read_b64_tr_b16 v[168:169], v14 offset:2048
    ds_read_b64_tr_b16 v[170:171], v14 offset:3072
    ds_read_b64_tr_b16 v[172:173], v15 offset:2048
    ds_read_b64_tr_b16 v[174:175], v15 offset:3072
    ds_read_b64_tr_b16 v[176:177], v14 offset:4096
    ds_read_b64_tr_b16 v[178:179], v14 offset:5120
    ds_read_b64_tr_b16 v[180:181], v15 offset:4096
    ds_read_b64_tr_b16 v[182:183], v15 offset:5120
    s_waitcnt lgkmcnt(8)
    ds_read_b64_tr_b16 v[184:185], v14 offset:6144
    ds_read_b64_tr_b16 v[186:187], v14 offset:7168
    ds_read_b64_tr_b16 v[188:189], v15 offset:6144
    ds_read_b64_tr_b16 v[190:191], v15 offset:7168
    s_add_u32 s31, s74, 12288
    s_sub_u32 s75, s31, 28672
    s_min_u32 s31, s31, s75
    s_add_u32 m0, s73, 0
    s_lshl4_add_u32 s31, s31, s72
    buffer_load_dwordx4 v23, s[16:19], s31 offen lds
    s_add_u32 m0, s73, 1024
    s_add_u32 s31, s31, 8192
    buffer_load_dwordx4 v23, s[16:19], s31 offen lds
    s_waitcnt lgkmcnt(8)
    ds_read_b64_tr_b16 v[192:193], v14 offset:32768
    ds_read_b64_tr_b16 v[194:195], v14 offset:33792
    ds_read_b64_tr_b16 v[196:197], v15 offset:32768
    ds_read_b64_tr_b16 v[198:199], v15 offset:33792
    s_add_u32 s31, s74, 13312
    s_sub_u32 s75, s31, 28672
    s_min_u32 s31, s31, s75
    s_add_u32 m0, s73, 2048
    s_lshl4_add_u32 s31, s31, s72
    buffer_load_dwordx4 v23, s[16:19], s31 offen lds
    s_add_u32 m0, s73, 3072
    s_add_u32 s31, s31, 8192
    buffer_load_dwordx4 v23, s[16:19], s31 offen lds
    s_waitcnt lgkmcnt(8)
    ds_read_b64_tr_b16 v[200:201], v14 offset:34816
    ds_read_b64_tr_b16 v[202:203], v14 offset:35840
    ds_read_b64_tr_b16 v[204:205], v15 offset:34816
    ds_read_b64_tr_b16 v[206:207], v15 offset:35840
    s_add_u32 s31, s74, 14336
    s_sub_u32 s75, s31, 28672
    s_min_u32 s31, s31, s75
    s_add_u32 m0, s73, 4096
    s_lshl4_add_u32 s31, s31, s72
    buffer_load_dwordx4 v23, s[16:19], s31 offen lds
    s_add_u32 m0, s73, 5120
    s_add_u32 s31, s31, 8192
    buffer_load_dwordx4 v23, s[16:19], s31 offen lds
    s_waitcnt lgkmcnt(8)
    ds_read_b64_tr_b16 v[208:209], v14 offset:36864
    ds_read_b64_tr_b16 v[210:211], v14 offset:37888
    ds_read_b64_tr_b16 v[212:213], v15 offset:36864
    ds_read_b64_tr_b16 v[214:215], v15 offset:37888
    s_add_u32 s31, s74, 15360
    s_sub_u32 s75, s31, 28672
    s_min_u32 s31, s31, s75
    s_add_u32 m0, s73, 6144
    s_lshl4_add_u32 s31, s31, s72
    buffer_load_dwordx4 v23, s[16:19], s31 offen lds
    s_add_u32 m0, s73, 7168
    s_add_u32 s31, s31, 8192
    buffer_load_dwordx4 v23, s[16:19], s31 offen lds
    s_waitcnt lgkmcnt(8)
    ds_read_b64_tr_b16 v[216:217], v14 offset:38912
    ds_read_b64_tr_b16 v[218:219], v14 offset:39936
    ds_read_b64_tr_b16 v[220:221], v15 offset:38912
    ds_read_b64_tr_b16 v[222:223], v15 offset:39936
    s_add_u32 s31, s74, 16384
    s_sub_u32 s75, s31, 28672
    s_min_u32 s31, s31, s75
    s_add_u32 m0, s73, 32768
    s_lshl4_add_u32 s31, s31, s72
    buffer_load_dwordx4 v23, s[16:19], s31 offen lds
    s_add_u32 m0, s73, 33792
    s_add_u32 s31, s31, 8192
    buffer_load_dwordx4 v23, s[16:19], s31 offen lds
    s_waitcnt lgkmcnt(8)
    ds_read_b64_tr_b16 v[224:225], v16 offset:0
    ds_read_b64_tr_b16 v[226:227], v16 offset:1024
    ds_read_b64_tr_b16 v[228:229], v17 offset:0
    ds_read_b64_tr_b16 v[230:231], v17 offset:1024
    s_add_u32 s31, s74, 17408
    s_sub_u32 s75, s31, 28672
    s_min_u32 s31, s31, s75
    s_add_u32 m0, s73, 34816
    s_lshl4_add_u32 s31, s31, s72
    buffer_load_dwordx4 v23, s[16:19], s31 offen lds
    s_add_u32 m0, s73, 35840
    s_add_u32 s31, s31, 8192
    buffer_load_dwordx4 v23, s[16:19], s31 offen lds
    s_waitcnt lgkmcnt(8)
    ds_read_b64_tr_b16 v[232:233], v16 offset:2048
    ds_read_b64_tr_b16 v[234:235], v16 offset:3072
    ds_read_b64_tr_b16 v[236:237], v17 offset:2048
    ds_read_b64_tr_b16 v[238:239], v17 offset:3072
    s_add_u32 s31, s74, 18432
    s_sub_u32 s75, s31, 28672
    s_min_u32 s31, s31, s75
    s_add_u32 m0, s73, 36864
    s_lshl4_add_u32 s31, s31, s72
    buffer_load_dwordx4 v23, s[16:19], s31 offen lds
    s_add_u32 m0, s73, 37888
    s_add_u32 s31, s31, 8192
    buffer_load_dwordx4 v23, s[16:19], s31 offen lds
    s_waitcnt lgkmcnt(8)
    ds_read_b64_tr_b16 v[240:241], v16 offset:4096
    ds_read_b64_tr_b16 v[242:243], v16 offset:5120
    ds_read_b64_tr_b16 v[244:245], v17 offset:4096
    ds_read_b64_tr_b16 v[246:247], v17 offset:5120
    s_add_u32 s31, s74, 19456
    s_sub_u32 s75, s31, 28672
    s_min_u32 s31, s31, s75
    s_add_u32 m0, s73, 38912
    s_lshl4_add_u32 s31, s31, s72
    buffer_load_dwordx4 v23, s[16:19], s31 offen lds
    s_add_u32 m0, s73, 39936
    s_add_u32 s31, s31, 8192
    buffer_load_dwordx4 v23, s[16:19], s31 offen lds
    s_waitcnt lgkmcnt(8)
    ds_read_b64_tr_b16 v[248:249], v16 offset:6144
    ds_read_b64_tr_b16 v[250:251], v16 offset:7168
    ds_read_b64_tr_b16 v[252:253], v17 offset:6144
    ds_read_b64_tr_b16 v[254:255], v17 offset:7168
    s_add_u32 s31, s74, 20480
    s_sub_u32 s75, s31, 28672
    s_min_u32 s31, s31, s75
    s_add_u32 m0, s73, 65536
    s_lshl4_add_u32 s31, s31, s72
    buffer_load_dwordx4 v23, s[16:19], s31 offen lds
    s_add_u32 m0, s73, 66560
    s_add_u32 s31, s31, 8192
    buffer_load_dwordx4 v23, s[16:19], s31 offen lds
    s_waitcnt lgkmcnt(8)
    s_add_u32 s31, s74, 21504
    s_sub_u32 s75, s31, 28672
    s_min_u32 s31, s31, s75
    s_add_u32 m0, s73, 67584
    s_lshl4_add_u32 s31, s31, s72
    buffer_load_dwordx4 v23, s[16:19], s31 offen lds
    s_add_u32 m0, s73, 68608
    s_add_u32 s31, s31, 8192
    buffer_load_dwordx4 v23, s[16:19], s31 offen lds
    s_waitcnt lgkmcnt(4)
    buffer_load_dword v26, v22, s[12:15], s26 offen sc1
    s_add_u32 s31, s74, 22528
    s_sub_u32 s75, s31, 28672
    s_min_u32 s31, s31, s75
    s_add_u32 m0, s73, 69632
    s_lshl4_add_u32 s31, s31, s72
    buffer_load_dwordx4 v23, s[16:19], s31 offen lds
    s_add_u32 m0, s73, 70656
    s_add_u32 s31, s31, 8192
    buffer_load_dwordx4 v23, s[16:19], s31 offen lds
    s_waitcnt lgkmcnt(0)
    s_add_u32 s31, s74, 23552
    s_sub_u32 s75, s31, 28672
    s_min_u32 s31, s31, s75
    s_add_u32 m0, s73, 71680
    s_lshl4_add_u32 s31, s31, s72
    buffer_load_dwordx4 v23, s[16:19], s31 offen lds
    s_add_u32 m0, s73, 72704
    s_add_u32 s31, s31, 8192
    buffer_load_dwordx4 v23, s[16:19], s31 offen lds
    s_waitcnt vmcnt(4)
    v_cmp_ne_u32 vcc, s76, v26
    s_nop 0
    s_cbranch_vccz L_g2_go
L_g2_poll:
    buffer_load_dword v26, v22, s[12:15], s26 offen sc1
    s_add_u32 s30, s30, 1
    s_waitcnt vmcnt(0)
    v_cmp_ne_u32 vcc, s76, v26
    s_cmp_gt_u32 s30, 262144
    s_cbranch_scc1 L_g2_go
    s_cbranch_vccnz L_g2_poll
L_g2_go:
    s_add_u32 s31, s74, 0
    s_sub_u32 s75, s31, 28672
    s_min_u32 s31, s31, s75
    s_add_u32 s27, s31, s24
    s_add_u32 s31, s31, s25
    buffer_load_dwordx4 v[88:91], v13, s[12:15], s27 offen sc1
    buffer_load_dwordx4 v[92:95], v13, s[12:15], s31 offen sc1
    s_add_u32 s31, s74, 1024
    s_sub_u32 s75, s31, 28672
    s_min_u32 s31, s31, s75
    s_add_u32 s27, s31, s24
    s_add_u32 s31, s31, s25
    buffer_load_dwordx4 v[96:99], v13, s[12:15], s27 offen sc1
    buffer_load_dwordx4 v[100:103], v13, s[12:15], s31 offen sc1
    s_add_u32 s31, s74, 12288
    s_sub_u32 s75, s31, 28672
    s_min_u32 s31, s31, s75
    s_add_u32 s27, s31, s24
    s_add_u32 s31, s31, s25
    buffer_load_dwordx4 v[104:107], v13, s[12:15], s27 offen sc1
    buffer_load_dwordx4 v[108:111], v13, s[12:15], s31 offen sc1
    s_add_u32 s31, s74, 13312
    s_sub_u32 s75, s31, 28672
    s_min_u32 s31, s31, s75
    s_add_u32 s27, s31, s24
    s_add_u32 s31, s31, s25
    buffer_load_dwordx4 v[112:115], v13, s[12:15], s27 offen sc1
    buffer_load_dwordx4 v[116:119], v13, s[12:15], s31 offen sc1
    s_add_u32 s31, s74, 14336
    s_sub_u32 s75, s31, 28672
    s_min_u32 s31, s31, s75
    s_add_u32 s27, s31, s24
    s_add_u32 s31, s31, s25
    buffer_load_dwordx4 v[120:123], v13, s[12:15], s27 offen sc1
    buffer_load_dwordx4 v[124:127], v13, s[12:15], s31 offen sc1
    s_add_u32 s31, s74, 15360
    s_sub_u32 s75, s31, 28672
    s_min_u32 s31, s31, s75
    s_add_u32 s27, s31, s24
    s_add_u32 s31, s31, s25
    buffer_load_dwordx4 v[128:131], v13, s[12:15], s27 offen sc1
    buffer_load_dwordx4 v[132:135], v13, s[12:15], s31 offen sc1
    s_add_u32 s31, s74, 16384
    s_sub_u32 s75, s31, 28672
    s_min_u32 s31, s31, s75
    s_add_u32 s27, s31, s24
    s_add_u32 s31, s31, s25
    buffer_load_dwordx4 v[136:139], v13, s[12:15], s27 offen sc1
    buffer_load_dwordx4 v[140:143], v13, s[12:15], s31 offen sc1
    s_add_u32 s31, s74, 17408
    s_sub_u32 s75, s31, 28672
    s_min_u32 s31, s31, s75
    s_add_u32 s27, s31, s24
    s_add_u32 s31, s31, s25
    buffer_load_dwordx4 v[144:147], v13, s[12:15], s27 offen sc1
    buffer_load_dwordx4 v[148:151], v13, s[12:15], s31 offen sc1
    s_add_u32 s31, s74, 18432
    s_sub_u32 s75, s31, 28672
    s_min_u32 s31, s31, s75
    s_add_u32 s27, s31, s24
    s_add_u32 s31, s31, s25
    buffer_load_dwordx4 v[152:155], v13, s[12:15], s27 offen sc1
    buffer_load_dwordx4 v[156:159], v13, s[12:15], s31 offen sc1
    s_setprio 0
    s_waitcnt vmcnt(16)
    v_mfma_f32_32x32x16_bf16 v[24:39], v[160:163], v[88:91], 0
    v_mfma_f32_32x32x16_bf16 v[40:55], v[164:167], v[88:91], 0
    v_mfma_f32_32x32x16_bf16 v[56:71], v[160:163], v[92:95], 0
    v_mfma_f32_32x32x16_bf16 v[72:87], v[164:167], v[92:95], 0
    s_waitcnt vmcnt(14)
    v_mfma_f32_32x32x16_bf16 v[24:39], v[168:171], v[96:99], v[24:39]
    ds_read_b64_tr_b16 v[160:161], v14 offset:0
    ds_read_b64_tr_b16 v[162:163], v14 offset:1024
    ds_read_b64_tr_b16 v[164:165], v15 offset:0
    ds_read_b64_tr_b16 v[166:167], v15 offset:1024
    v_mfma_f32_32x32x16_bf16 v[40:55], v[172:175], v[96:99], v[40:55]
    s_add_u32 s31, s74, 19456
    s_sub_u32 s75, s31, 28672
    s_min_u32 s31, s31, s75
    s_add_u32 s27, s31, s24
    s_add_u32 s31, s31, s25
    buffer_load_dwordx4 v[88:91], v13, s[12:15], s27 offen sc1
    buffer_load_dwordx4 v[92:95], v13, s[12:15], s31 offen sc1
    v_mfma_f32_32x32x16_bf16 v[56:71], v[168:171], v[100:103], v[56:71]
    v_mfma_f32_32x32x16_bf16 v[72:87], v[172:175], v[100:103], v[72:87]
    s_waitcnt lgkmcnt(0)
    s_waitcnt vmcnt(14)
    v_mfma_f32_32x32x16_bf16 v[24:39], v[160:163], v[104:107], v[24:39]
    ds_read_b64_tr_b16 v[168:169], v14 offset:2048
    ds_read_b64_tr_b16 v[170:171], v14 offset:3072
    ds_read_b64_tr_b16 v[172:173], v15 offset:2048
    ds_read_b64_tr_b16 v[174:175], v15 offset:3072
    v_mfma_f32_32x32x16_bf16 v[40:55], v[164:167], v[104:107], v[40:55]
    s_add_u32 s31, s74, 20480
    s_sub_u32 s75, s31, 28672
    s_min_u32 s31, s31, s75
    s_add_u32 s27, s31, s24
    s_add_u32 s31, s31, s25
    buffer_load_dwordx4 v[96:99], v13, s[12:15], s27 offen sc1
    buffer_load_dwordx4 v[100:103], v13, s[12:15], s31 offen sc1
    v_mfma_f32_32x32x16_bf16 v[56:71], v[160:163], v[108:111], v[56:71]
    s_add_u32 s31, s74, 24576
    s_sub_u32 s75, s31, 28672
    s_min_u32 s31, s31, s75
    s_add_u32 m0, s73, 0
    s_lshl4_add_u32 s31, s31, s72
    buffer_load_dwordx4 v23, s[16:19], s31 offen lds
    s_add_u32 m0, s73, 1024
    s_add_u32 s31, s31, 8192
    buffer_load_dwordx4 v23, s[16:19], s31 offen lds
    v_mfma_f32_32x32x16_bf16 v[72:87], v[164:167], v[108:111], v[72:87]
    s_waitcnt lgkmcnt(0)
    s_waitcnt vmcnt(16)
    v_mfma_f32_32x32x16_bf16 v[24:39], v[168:171], v[112:115], v[24:39]
    ds_read_b64_tr_b16 v[160:161], v14 offset:4096
    ds_read_b64_tr_b16 v[162:163], v14 offset:5120
    ds_read_b64_tr_b16 v[164:165], v15 offset:4096
    ds_read_b64_tr_b16 v[166:167], v15 offset:5120
    v_mfma_f32_32x32x16_bf16 v[40:55], v[172:175], v[112:115], v[40:55]
    s_add_u32 s31, s74, 21504
    s_sub_u32 s75, s31, 28672
    s_min_u32 s31, s31, s75
    s_add_u32 s27, s31, s24
    s_add_u32 s31, s31, s25
    buffer_load_dwordx4 v[104:107], v13, s[12:15], s27 offen sc1
    buffer_load_dwordx4 v[108:111], v13, s[12:15], s31 offen sc1
    v_mfma_f32_32x32x16_bf16 v[56:71], v[168:171], v[116:119], v[56:71]
    s_add_u32 s31, s74, 25600
    s_sub_u32 s75, s31, 28672
    s_min_u32 s31, s31, s75
    s_add_u32 m0, s73, 2048
    s_lshl4_add_u32 s31, s31, s72
    buffer_load_dwordx4 v23, s[16:19], s31 offen lds
    s_add_u32 m0, s73, 3072
    s_add_u32 s31, s31, 8192
    buffer_load_dwordx4 v23, s[16:19], s31 offen lds
    v_mfma_f32_32x32x16_bf16 v[72:87], v[172:175], v[116:119], v[72:87]
    s_waitcnt lgkmcnt(0)
    s_waitcnt vmcnt(18)
    v_mfma_f32_32x32x16_bf16 v[24:39], v[160:163], v[120:123], v[24:39]
    ds_read_b64_tr_b16 v[168:169], v14 offset:6144
    ds_read_b64_tr_b16 v[170:171], v14 offset:7168
    ds_read_b64_tr_b16 v[172:173], v15 offset:6144
    ds_read_b64_tr_b16 v[174:175], v15 offset:7168
    v_mfma_f32_32x32x16_bf16 v[40:55], v[164:167], v[120:123], v[40:55]
    s_add_u32 s31, s74, 22528
    s_sub_u32 s75, s31, 28672
    s_min_u32 s31, s31, s75
    s_add_u32 s27, s31, s24
    s_add_u32 s31, s31, s25
    buffer_load_dwordx4 v[112:115], v13, s[12:15], s27 offen sc1
    buffer_load_dwordx4 v[116:119], v13, s[12:15], s31 offen sc1
    v_mfma_f32_32x32x16_bf16 v[56:71], v[160:163], v[124:127], v[56:71]
    s_add_u32 s31, s74, 26624
    s_sub_u32 s75, s31, 28672
    s_min_u32 s31, s31, s75
    s_add_u32 m0, s73, 4096
    s_lshl4_add_u32 s31, s31, s72
    buffer_load_dwordx4 v23, s[16:19], s31 offen lds
    s_add_u32 m0, s73, 5120
    s_add_u32 s31, s31, 8192
    buffer_load_dwordx4 v23, s[16:19], s31 offen lds
    v_mfma_f32_32x32x16_bf16 v[72:87], v[164:167], v[124:127], v[72:87]
    s_waitcnt lgkmcnt(0)
    s_waitcnt vmcnt(20)
    v_mfma_f32_32x32x16_bf16 v[24:39], v[168:171], v[128:131], v[24:39]
    ds_read_b64_tr_b16 v[160:161], v14 offset:32768
    ds_read_b64_tr_b16 v[162:163], v14 offset:33792
    ds_read_b64_tr_b16 v[164:165], v15 offset:32768
    ds_read_b64_tr_b16 v[166:167], v15 offset:33792
    v_mfma_f32_32x32x16_bf16 v[40:55], v[172:175], v[128:131], v[40:55]
    s_add_u32 s31, s74, 23552
    s_sub_u32 s75, s31, 28672
    s_min_u32 s31, s31, s75
    s_add_u32 s27, s31, s24
    s_add_u32 s31, s31, s25
    buffer_load_dwordx4 v[120:123], v13, s[12:15], s27 offen sc1
    buffer_load_dwordx4 v[124:127], v13, s[12:15], s31 offen sc1
    v_mfma_f32_32x32x16_bf16 v[56:71], v[168:171], v[132:135], v[56:71]
    s_add_u32 s31, s74, 27648
    s_sub_u32 s75, s31, 28672
    s_min_u32 s31, s31, s75
    s_add_u32 m0, s73, 6144
    s_lshl4_add_u32 s31, s31, s72
    buffer_load_dwordx4 v23, s[16:19], s31 offen lds
    s_add_u32 m0, s73, 7168
    s_add_u32 s31, s31, 8192
    buffer_load_dwordx4 v23, s[16:19], s31 offen lds
    v_mfma_f32_32x32x16_bf16 v[72:87], v[172:175], v[132:135], v[72:87]
    s_waitcnt lgkmcnt(0)
    s_waitcnt vmcnt(22)
    v_mfma_f32_32x32x16_bf16 v[24:39], v[160:163], v[136:139], v[24:39]
    ds_read_b64_tr_b16 v[168:169], v14 offset:34816
    ds_read_b64_tr_b16 v[170:171], v14 offset:35840
    ds_read_b64_tr_b16 v[172:173], v15 offset:34816
    ds_read_b64_tr_b16 v[174:175], v15 offset:35840
    v_mfma_f32_32x32x16_bf16 v[40:55], v[164:167], v[136:139], v[40:55]
    s_add_u32 s31, s74, 2048
    s_sub_u32 s75, s31, 28672
    s_min_u32 s31, s31, s75
    s_add_u32 s27, s31, s24
    s_add_u32 s31, s31, s25
    buffer_load_dwordx4 v[128:131], v13, s[12:15], s27 offen sc1
    buffer_load_dwordx4 v[132:135], v13, s[12:15], s31 offen sc1
    v_mfma_f32_32x32x16_bf16 v[56:71], v[160:163], v[140:143], v[56:71]
    v_mfma_f32_32x32x16_bf16 v[72:87], v[164:167], v[140:143], v[72:87]
    s_waitcnt lgkmcnt(0)
    s_waitcnt vmcnt(22)
    v_mfma_f32_32x32x16_bf16 v[24:39], v[168:171], v[144:147], v[24:39]
    ds_read_b64_tr_b16 v[160:161], v14 offset:36864
    ds_read_b64_tr_b16 v[162:163], v14 offset:37888
    ds_read_b64_tr_b16 v[164:165], v15 offset:36864
    ds_read_b64_tr_b16 v[166:167], v15 offset:37888
    v_mfma_f32_32x32x16_bf16 v[40:55], v[172:175], v[144:147], v[40:55]
    s_add_u32 s31, s74, 3072
    s_sub_u32 s75, s31, 28672
    s_min_u32 s31, s31, s75
    s_add_u32 s27, s31, s24
    s_add_u32 s31, s31, s25
    buffer_load_dwordx4 v[136:139], v13, s[12:15], s27 offen sc1
    buffer_load_dwordx4 v[140:143], v13, s[12:15], s31 offen sc1
    v_mfma_f32_32x32x16_bf16 v[56:71], v[168:171], v[148:151], v[56:71]
    v_mfma_f32_32x32x16_bf16 v[72:87], v[172:175], v[148:151], v[72:87]
    s_waitcnt lgkmcnt(0)
    s_waitcnt vmcnt(22)
    v_mfma_f32_32x32x16_bf16 v[24:39], v[160:163], v[152:155], v[24:39]
    ds_read_b64_tr_b16 v[168:169], v14 offset:38912
    ds_read_b64_tr_b16 v[170:171], v14 offset:39936
    ds_read_b64_tr_b16 v[172:173], v15 offset:38912
    ds_read_b64_tr_b16 v[174:175], v15 offset:39936
    v_mfma_f32_32x32x16_bf16 v[40:55], v[164:167], v[152:155], v[40:55]
    s_add_u32 s31, s74, 4096
    s_sub_u32 s75, s31, 28672
    s_min_u32 s31, s31, s75
    s_add_u32 s27, s31, s24
    s_add_u32 s31, s31, s25
    buffer_load_dwordx4 v[144:147], v13, s[12:15], s27 offen sc1
    buffer_load_dwordx4 v[148:151], v13, s[12:15], s31 offen sc1
    v_mfma_f32_32x32x16_bf16 v[56:71], v[160:163], v[156:159], v[56:71]
    v_mfma_f32_32x32x16_bf16 v[72:87], v[164:167], v[156:159], v[72:87]
    s_waitcnt lgkmcnt(0)
    s_waitcnt vmcnt(22)
    v_mfma_f32_32x32x16_bf16 v[24:39], v[168:171], v[88:91], v[24:39]
    ds_read_b64_tr_b16 v[160:161], v16 offset:0
    ds_read_b64_tr_b16 v[162:163], v16 offset:1024
    ds_read_b64_tr_b16 v[164:165], v17 offset:0
    ds_read_b64_tr_b16 v[166:167], v17 offset:1024
    v_mfma_f32_32x32x16_bf16 v[40:55], v[172:175], v[88:91], v[40:55]
    s_add_u32 s31, s74, 5120
    s_sub_u32 s75, s31, 28672
    s_min_u32 s31, s31, s75
    s_add_u32 s27, s31, s24
    s_add_u32 s31, s31, s25
    buffer_load_dwordx4 v[152:155], v13, s[12:15], s27 offen sc1
    buffer_load_dwordx4 v[156:159], v13, s[12:15], s31 offen sc1
    v_mfma_f32_32x32x16_bf16 v[56:71], v[168:171], v[92:95], v[56:71]
    v_mfma_f32_32x32x16_bf16 v[72:87], v[172:175], v[92:95], v[72:87]
    s_waitcnt lgkmcnt(0)
    s_waitcnt vmcnt(22)
    v_mfma_f32_32x32x16_bf16 v[24:39], v[160:163], v[96:99], v[24:39]
    ds_read_b64_tr_b16 v[168:169], v16 offset:2048
    ds_read_b64_tr_b16 v[170:171], v16 offset:3072
    ds_read_b64_tr_b16 v[172:173], v17 offset:2048
    ds_read_b64_tr_b16 v[174:175], v17 offset:3072
    v_mfma_f32_32x32x16_bf16 v[40:55], v[164:167], v[96:99], v[40:55]
    s_add_u32 s31, s74, 6144
    s_sub_u32 s75, s31, 28672
    s_min_u32 s31, s31, s75
    s_add_u32 s27, s31, s24
    s_add_u32 s31, s31, s25
    buffer_load_dwordx4 v[88:91], v13, s[12:15], s27 offen sc1
    buffer_load_dwordx4 v[92:95], v13, s[12:15], s31 offen sc1
    v_mfma_f32_32x32x16_bf16 v[56:71], v[160:163], v[100:103], v[56:71]
    v_mfma_f32_32x32x16_bf16 v[72:87], v[164:167], v[100:103], v[72:87]
    s_waitcnt lgkmcnt(0)
    s_waitcnt vmcnt(20)
    v_mfma_f32_32x32x16_bf16 v[24:39], v[168:171], v[104:107], v[24:39]
    ds_read_b64_tr_b16 v[160:161], v16 offset:4096
    ds_read_b64_tr_b16 v[162:163], v16 offset:5120
    ds_read_b64_tr_b16 v[164:165], v17 offset:4096
    ds_read_b64_tr_b16 v[166:167], v17 offset:5120
    v_mfma_f32_32x32x16_bf16 v[40:55], v[172:175], v[104:107], v[40:55]
    s_add_u32 s31, s74, 7168
    s_sub_u32 s75, s31, 28672
    s_min_u32 s31, s31, s75
    s_add_u32 s27, s31, s24
    s_add_u32 s31, s31, s25
    buffer_load_dwordx4 v[96:99], v13, s[12:15], s27 offen sc1
    buffer_load_dwordx4 v[100:103], v13, s[12:15], s31 offen sc1
    v_mfma_f32_32x32x16_bf16 v[56:71], v[168:171], v[108:111], v[56:71]
    v_mfma_f32_32x32x16_bf16 v[72:87], v[172:175], v[108:111], v[72:87]
    s_waitcnt lgkmcnt(0)
    s_waitcnt vmcnt(18)
    v_mfma_f32_32x32x16_bf16 v[24:39], v[160:163], v[112:115], v[24:39]
    ds_read_b64_tr_b16 v[168:169], v16 offset:6144
    ds_read_b64_tr_b16 v[170:171], v16 offset:7168
    ds_read_b64_tr_b16 v[172:173], v17 offset:6144
    ds_read_b64_tr_b16 v[174:175], v17 offset:7168
    v_mfma_f32_32x32x16_bf16 v[40:55], v[164:167], v[112:115], v[40:55]
    s_add_u32 s31, s74, 8192
    s_sub_u32 s75, s31, 28672
    s_min_u32 s31, s31, s75
    s_add_u32 s27, s31, s24
    s_add_u32 s31, s31, s25
    buffer_load_dwordx4 v[104:107], v13, s[12:15], s27 offen sc1
    buffer_load_dwordx4 v[108:111], v13, s[12:15], s31 offen sc1
    v_mfma_f32_32x32x16_bf16 v[56:71], v[160:163], v[116:119], v[56:71]
    v_mfma_f32_32x32x16_bf16 v[72:87], v[164:167], v[116:119], v[72:87]
    s_waitcnt lgkmcnt(0)
    s_waitcnt vmcnt(16)
    v_mfma_f32_32x32x16_bf16 v[24:39], v[168:171], v[120:123], v[24:39]
    v_mfma_f32_32x32x16_bf16 v[40:55], v[172:175], v[120:123], v[40:55]
    s_add_u32 s31, s74, 9216
    s_sub_u32 s75, s31, 28672
    s_min_u32 s31, s31, s75
    s_add_u32 s27, s31, s24
    s_add_u32 s31, s31, s25
    buffer_load_dwordx4 v[112:115], v13, s[12:15], s27 offen sc1
    buffer_load_dwordx4 v[116:119], v13, s[12:15], s31 offen sc1
    v_mfma_f32_32x32x16_bf16 v[56:71], v[168:171], v[124:127], v[56:71]
    v_mfma_f32_32x32x16_bf16 v[72:87], v[172:175], v[124:127], v[72:87]
    s_waitcnt vmcnt(14)
    v_mfma_f32_32x32x16_bf16 v[24:39], v[176:179], v[128:131], v[24:39]
    v_mfma_f32_32x32x16_bf16 v[40:55], v[180:183], v[128:131], v[40:55]
    s_add_u32 s31, s74, 10240
    s_sub_u32 s75, s31, 28672
    s_min_u32 s31, s31, s75
    s_add_u32 s27, s31, s24
    s_add_u32 s31, s31, s25
    buffer_load_dwordx4 v[120:123], v13, s[12:15], s27 offen sc1
    buffer_load_dwordx4 v[124:127], v13, s[12:15], s31 offen sc1
    v_mfma_f32_32x32x16_bf16 v[56:71], v[176:179], v[132:135], v[56:71]
    v_mfma_f32_32x32x16_bf16 v[72:87], v[180:183], v[132:135], v[72:87]
    s_waitcnt vmcnt(14)
    v_mfma_f32_32x32x16_bf16 v[24:39], v[184:187], v[136:139], v[24:39]
    v_mfma_f32_32x32x16_bf16 v[40:55], v[188:191], v[136:139], v[40:55]
    s_add_u32 s31, s74, 11264
    s_sub_u32 s75, s31, 28672
    s_min_u32 s31, s31, s75
    s_add_u32 s27, s31, s24
    s_add_u32 s31, s31, s25
    buffer_load_dwordx4 v[128:131], v13, s[12:15], s27 offen sc1
    buffer_load_dwordx4 v[132:135], v13, s[12:15], s31 offen sc1
    v_mfma_f32_32x32x16_bf16 v[56:71], v[184:187], v[140:143], v[56:71]
    v_mfma_f32_32x32x16_bf16 v[72:87], v[188:191], v[140:143], v[72:87]
    s_waitcnt vmcnt(14)
    v_mfma_f32_32x32x16_bf16 v[24:39], v[192:195], v[144:147], v[24:39]
    v_mfma_f32_32x32x16_bf16 v[40:55], v[196:199], v[144:147], v[40:55]
    s_add_u32 s31, s74, 24576
    s_sub_u32 s75, s31, 28672
    s_min_u32 s31, s31, s75
    s_add_u32 s27, s31, s24
    s_add_u32 s31, s31, s25
    buffer_load_dwordx4 v[136:139], v13, s[12:15], s27 offen sc1
    buffer_load_dwordx4 v[140:143], v13, s[12:15], s31 offen sc1
    v_mfma_f32_32x32x16_bf16 v[56:71], v[192:195], v[148:151], v[56:71]
    v_mfma_f32_32x32x16_bf16 v[72:87], v[196:199], v[148:151], v[72:87]
    s_waitcnt vmcnt(14)
    v_mfma_f32_32x32x16_bf16 v[24:39], v[200:203], v[152:155], v[24:39]
    v_mfma_f32_32x32x16_bf16 v[40:55], v[204:207], v[152:155], v[40:55]
    s_add_u32 s31, s74, 25600
    s_sub_u32 s75, s31, 28672
    s_min_u32 s31, s31, s75
    s_add_u32 s27, s31, s24
    s_add_u32 s31, s31, s25
    buffer_load_dwordx4 v[144:147], v13, s[12:15], s27 offen sc1
    buffer_load_dwordx4 v[148:151], v13, s[12:15], s31 offen sc1
    v_mfma_f32_32x32x16_bf16 v[56:71], v[200:203], v[156:159], v[56:71]
    v_mfma_f32_32x32x16_bf16 v[72:87], v[204:207], v[156:159], v[72:87]
    s_waitcnt vmcnt(14)
    v_mfma_f32_32x32x16_bf16 v[24:39], v[208:211], v[88:91], v[24:39]
    v_mfma_f32_32x32x16_bf16 v[40:55], v[212:215], v[88:91], v[40:55]
    s_add_u32 s31, s74, 26624
    s_sub_u32 s75, s31, 28672
    s_min_u32 s31, s31, s75
    s_add_u32 s27, s31, s24
    s_add_u32 s31, s31, s25
    buffer_load_dwordx4 v[152:155], v13, s[12:15], s27 offen sc1
    buffer_load_dwordx4 v[156:159], v13, s[12:15], s31 offen sc1
    v_mfma_f32_32x32x16_bf16 v[56:71], v[208:211], v[92:95], v[56:71]
    v_mfma_f32_32x32x16_bf16 v[72:87], v[212:215], v[92:95], v[72:87]
    s_waitcnt vmcnt(14)
    v_mfma_f32_32x32x16_bf16 v[24:39], v[216:219], v[96:99], v[24:39]
    v_mfma_f32_32x32x16_bf16 v[40:55], v[220:223], v[96:99], v[40:55]
    s_add_u32 s31, s74, 27648
    s_sub_u32 s75, s31, 28672
    s_min_u32 s31, s31, s75
    s_add_u32 s27, s31, s24
    s_add_u32 s31, s31, s25
    buffer_load_dwordx4 v[88:91], v13, s[12:15], s27 offen sc1
    buffer_load_dwordx4 v[92:95], v13, s[12:15], s31 offen sc1
    v_mfma_f32_32x32x16_bf16 v[56:71], v[216:219], v[100:103], v[56:71]
    s_lshl_b32 s28, s20, 2
    s_add_u32 s28, s28, 157232
    v_mov_b32 v22, s28
    v_mov_b32 v160, 1
    ds_write_b32 v22, v160
    v_mfma_f32_32x32x16_bf16 v[72:87], v[220:223], v[100:103], v[72:87]
    s_waitcnt vmcnt(14)
    v_mfma_f32_32x32x16_bf16 v[24:39], v[224:227], v[104:107], v[24:39]
    ds_read_b64_tr_b16 v[160:161], v14 offset:0
    ds_read_b64_tr_b16 v[162:163], v14 offset:1024
    ds_read_b64_tr_b16 v[164:165], v15 offset:0
    ds_read_b64_tr_b16 v[166:167], v15 offset:1024
    v_mfma_f32_32x32x16_bf16 v[40:55], v[228:231], v[104:107], v[40:55]
    v_mfma_f32_32x32x16_bf16 v[56:71], v[224:227], v[108:111], v[56:71]
    v_mfma_f32_32x32x16_bf16 v[72:87], v[228:231], v[108:111], v[72:87]
    s_waitcnt vmcnt(12)
    v_mfma_f32_32x32x16_bf16 v[24:39], v[232:235], v[112:115], v[24:39]
    ds_read_b64_tr_b16 v[168:169], v14 offset:2048
    ds_read_b64_tr_b16 v[170:171], v14 offset:3072
    ds_read_b64_tr_b16 v[172:173], v15 offset:2048
    ds_read_b64_tr_b16 v[174:175], v15 offset:3072
    v_mfma_f32_32x32x16_bf16 v[40:55], v[236:239], v[112:115], v[40:55]
    v_mfma_f32_32x32x16_bf16 v[56:71], v[232:235], v[116:119], v[56:71]
    v_mfma_f32_32x32x16_bf16 v[72:87], v[236:239], v[116:119], v[72:87]
    s_waitcnt vmcnt(10)
    v_mfma_f32_32x32x16_bf16 v[24:39], v[240:243], v[120:123], v[24:39]
    ds_read_b64_tr_b16 v[176:177], v14 offset:4096
    ds_read_b64_tr_b16 v[178:179], v14 offset:5120
    ds_read_b64_tr_b16 v[180:181], v15 offset:4096
    ds_read_b64_tr_b16 v[182:183], v15 offset:5120
    v_mfma_f32_32x32x16_bf16 v[40:55], v[244:247], v[120:123], v[40:55]
    v_mfma_f32_32x32x16_bf16 v[56:71], v[240:243], v[124:127], v[56:71]
    v_mfma_f32_32x32x16_bf16 v[72:87], v[244:247], v[124:127], v[72:87]
    s_waitcnt vmcnt(8)
    v_mfma_f32_32x32x16_bf16 v[24:39], v[248:251], v[128:131], v[24:39]
    ds_read_b64_tr_b16 v[184:185], v14 offset:6144
    ds_read_b64_tr_b16 v[186:187], v14 offset:7168
    ds_read_b64_tr_b16 v[188:189], v15 offset:6144
    ds_read_b64_tr_b16 v[190:191], v15 offset:7168
    v_mfma_f32_32x32x16_bf16 v[40:55], v[252:255], v[128:131], v[40:55]
    v_mfma_f32_32x32x16_bf16 v[56:71], v[248:251], v[132:135], v[56:71]
    v_mfma_f32_32x32x16_bf16 v[72:87], v[252:255], v[132:135], v[72:87]
    s_waitcnt lgkmcnt(0)
    s_waitcnt vmcnt(0)
    v_mfma_f32_32x32x16_bf16 v[24:39], v[160:163], v[136:139], v[24:39]
    v_mfma_f32_32x32x16_bf16 v[24:39], v[168:171], v[144:147], v[24:39]
    v_mfma_f32_32x32x16_bf16 v[24:39], v[176:179], v[152:155], v[24:39]
    v_mfma_f32_32x32x16_bf16 v[24:39], v[184:187], v[88:91], v[24:39]
    v_mfma_f32_32x32x16_bf16 v[40:55], v[164:167], v[136:139], v[40:55]
    v_mfma_f32_32x32x16_bf16 v[40:55], v[172:175], v[144:147], v[40:55]
    s_nop 9
    ds_write_b128 v18, v[24:27] offset:0
    ds_write_b128 v19, v[28:31] offset:0
    v_mfma_f32_32x32x16_bf16 v[40:55], v[180:183], v[152:155], v[40:55]
    ds_write_b128 v20, v[32:35] offset:0
    ds_write_b128 v21, v[36:39] offset:0
    v_mfma_f32_32x32x16_bf16 v[40:55], v[188:191], v[88:91], v[40:55]
    v_mfma_f32_32x32x16_bf16 v[56:71], v[160:163], v[140:143], v[56:71]
    v_mfma_f32_32x32x16_bf16 v[56:71], v[168:171], v[148:151], v[56:71]
    s_nop 9
    ds_write_b128 v18, v[40:43] offset:128
    ds_write_b128 v19, v[44:47] offset:128
    v_mfma_f32_32x32x16_bf16 v[56:71], v[176:179], v[156:159], v[56:71]
    ds_write_b128 v20, v[48:51] offset:128
    ds_write_b128 v21, v[52:55] offset:128
    v_mfma_f32_32x32x16_bf16 v[56:71], v[184:187], v[92:95], v[56:71]
    v_mfma_f32_32x32x16_bf16 v[72:87], v[164:167], v[140:143], v[72:87]
    v_mfma_f32_32x32x16_bf16 v[72:87], v[172:175], v[148:151], v[72:87]
    s_nop 9
    ds_write_b128 v18, v[56:59] offset:32768
    ds_write_b128 v19, v[60:63] offset:32768
    v_mfma_f32_32x32x16_bf16 v[72:87], v[180:183], v[156:159], v[72:87]
    ds_write_b128 v20, v[64:67] offset:32768
    ds_write_b128 v21, v[68:71] offset:32768
    v_mfma_f32_32x32x16_bf16 v[72:87], v[188:191], v[92:95], v[72:87]
    s_nop 11
    ds_write_b128 v18, v[72:75] offset:32896
    ds_write_b128 v19, v[76:79] offset:32896
    ds_write_b128 v20, v[80:83] offset:32896
    ds_write_b128 v21, v[84:87] offset:32896
    s_waitcnt vmcnt(0) lgkmcnt(0)
    s_branch L_final
L_conv:
    s_nop 1
    s_setprio 1
    v_lshrrev_b32 v1, 3, v0
    v_and_b32 v2, 7, v0
    v_lshlrev_b32 v12, 10, v1
    v_lshl_add_u32 v12, v2, 4, v12
    v_lshlrev_b32 v3, 4, v2
    s_lshl_b32 s33, s78, 6
    s_lshl_b32 s28, s20, 3
    s_add_u32 s33, s33, s28
    s_lshl_b32 s33, s33, 10
    s_lshl_b32 s34, s79, 7
    s_add_u32 s33, s33, s34
    s_mov_b32 s21, s39
    s_lshr_b32 s35, s21, 1
    s_and_b32 s36, s21, 1
    s_mul_i32 s38, s35, 13056
    s_add_u32 s38, s38, 131072
    s_lshl_b32 s27, s21, 13
    s_add_u32 s27, s27, 98304
    s_xor_b32 s32, s27, 8192
    v_and_b32 v42, 15, v0
    v_lshrrev_b32 v43, 4, v0
    v_and_b32 v44, 1, v0
    v_mul_u32_u24 v44, 4162, v44
    s_lshl_b32 s31, s36, 8
    s_sub_u32 s31, s38, s31
    s_add_u32 s29, s31, 12128
    v_lshlrev_b32 v45, 1, v42
    v_sub_u32 v32, s29, v45
    v_lshl_add_u32 v32, v43, 4, v32
    v_sub_u32 v32, v32, v44
    v_subrev_u32 v33, 1024, v32
    v_subrev_u32 v34, 2048, v32
    v_subrev_u32 v35, 3072, v32
    v_lshl_add_u32 v19, v0, 4, s38
    s_add_u32 s29, s31, 288
    v_lshlrev_b32 v36, 5, v42
    v_lshl_add_u32 v36, v43, 4, v36
    v_add_u32 v36, s29, v36
    v_lshlrev_b32 v37, 5, v42
    v_lshl_add_u32 v37, v43, 3, v37
    v_add_u32 v38, s27, v37
    s_lshl_b32 s28, s36, 11
    s_add_u32 s28, s28, s38
    v_add_u32 v37, s28, v37
    v_lshl_add_u32 v39, v0, 4, s27
    v_lshl_add_u32 v40, v0, 4, s32
    v_mov_b32 v13, 1
    s_lshl_b32 s29, s21, 2
    s_add_u32 s29, s29, 157184
    v_mov_b32 v14, s29
    s_xor_b32 s29, s29, 4
    v_mov_b32 v15, s29
    v_lshlrev_b32 v18, 4, v0
L_cv_ex:
    ds_read_b32 v16, v15 offset:64
    s_waitcnt lgkmcnt(0)
    v_readfirstlane_b32 s28, v16
    s_nop 0
    s_cmp_eq_u32 s28, 1
    s_cbranch_scc0 L_cv_ex
    ds_read2_b32 v[144:145], v32 offset0:176 offset1:177
    ds_read2_b32 v[146:147], v32 offset0:178 offset1:179
    ds_read2_b32 v[148:149], v32 offset0:48 offset1:49
    ds_read2_b32 v[150:151], v32 offset0:50 offset1:51
    ds_read2_b32 v[152:153], v33 offset0:176 offset1:177
    ds_read2_b32 v[154:155], v33 offset0:178 offset1:179
    ds_read2_b32 v[156:157], v33 offset0:48 offset1:49
    ds_read2_b32 v[158:159], v33 offset0:50 offset1:51
    ds_read2_b32 v[160:161], v34 offset0:176 offset1:177
    ds_read2_b32 v[162:163], v34 offset0:178 offset1:179
    ds_read2_b32 v[164:165], v34 offset0:48 offset1:49
    ds_read2_b32 v[166:167], v34 offset0:50 offset1:51
    ds_read2_b32 v[168:169], v35 offset0:176 offset1:177
    ds_read2_b32 v[170:171], v35 offset0:178 offset1:179
    ds_read2_b32 v[172:173], v35 offset0:48 offset1:49
    ds_read2_b32 v[174:175], v35 offset0:50 offset1:51
    s_cmp_eq_u32 s37, 1
    s_cbranch_scc1 L_cv_uok
    s_mov_b32 s30, 0
L_us_poll:
    s_sleep 8
    s_lshl_b32 s29, s79, 6
    s_lshl_b32 s28, s39, 4
    s_add_u32 s29, s29, s28
    s_lshr_b32 s28, s78, 4
    s_lshl_b32 s28, s28, 9
    s_add_u32 s29, s29, s28
    s_lshl_b32 s29, s29, 2
    s_add_u32 s29, s29, 262144
    v_lshlrev_b32 v20, 2, v0
    v_add_u32 v20, 32768, v20
    v_and_b32 v21, 15, v0
    v_lshl_add_u32 v21, v21, 2, s29
    s_mov_b32 s28, 0
    s_mov_b32 s29, -1
    v_cndmask_b32 v20, v20, v21, s[28:29]
    buffer_load_dword v253, v20, s[12:15], 0 offen sc1
    s_add_u32 s30, s30, 1
    s_waitcnt vmcnt(0)
    v_cmp_ne_u32 vcc, s76, v253
    s_cmp_gt_u32 s30, 262144
    s_cbranch_scc1 L_us_ok
    s_cbranch_vccnz L_us_poll
L_us_ok:
    s_lshr_b32 s28, s39, 1
    s_lshl_b32 s29, s2, 1
    s_add_u32 s29, s29, s28
    s_lshl_b32 s29, s29, 7
    s_add_u32 s29, s29, 8388608
    s_mul_i32 s28, s28, 13056
    s_add_u32 m0, s28, 131584
    v_lshrrev_b32 v180, 3, v0
    v_and_b32 v181, 7, v0
    v_mul_u32_u24 v180, 67712, v180
    v_lshl_add_u32 v180, v181, 4, v180
    buffer_load_dwordx4 v180, s[12:15], s29 offen offset:0 sc1 lds
    s_add_u32 s29, s29, 540672
    buffer_load_dwordx4 v180, s[12:15], s29 offen offset:1024 sc1 lds
    s_add_u32 s29, s29, 540672
    buffer_load_dwordx4 v180, s[12:15], s29 offen offset:2048 sc1 lds
    s_add_u32 s29, s29, 540672
    buffer_load_dwordx4 v180, s[12:15], s29 offen offset:3072 sc1 lds
    s_waitcnt vmcnt(0)
L_cv_uok:
    s_waitcnt vmcnt(0)
    ds_read_b128 v[80:83], v36 offset:192
    ds_read_b128 v[84:87], v36 offset:704
    ds_read_b128 v[88:91], v36 offset:1216
    ds_read_b128 v[92:95], v36 offset:1728
    ds_read_b128 v[96:99], v36 offset:2240
    ds_read_b128 v[100:103], v36 offset:2752
    ds_read_b128 v[104:107], v36 offset:3264
    ds_read_b128 v[108:111], v36 offset:3776
    s_waitcnt lgkmcnt(7)
    v_mfma_f32_16x16x32_bf16 v[48:51], v[144:147], v[80:83], 0
    s_waitcnt lgkmcnt(6)
    v_mfma_f32_16x16x32_bf16 v[52:55], v[144:147], v[84:87], 0
    s_waitcnt lgkmcnt(5)
    v_mfma_f32_16x16x32_bf16 v[56:59], v[144:147], v[88:91], 0
    s_waitcnt lgkmcnt(4)
    v_mfma_f32_16x16x32_bf16 v[60:63], v[144:147], v[92:95], 0
    s_waitcnt lgkmcnt(3)
    v_mfma_f32_16x16x32_bf16 v[64:67], v[144:147], v[96:99], 0
    s_waitcnt lgkmcnt(2)
    v_mfma_f32_16x16x32_bf16 v[68:71], v[144:147], v[100:103], 0
    s_waitcnt lgkmcnt(1)
    v_mfma_f32_16x16x32_bf16 v[72:75], v[144:147], v[104:107], 0
    s_waitcnt lgkmcnt(0)
    v_mfma_f32_16x16x32_bf16 v[76:79], v[144:147], v[108:111], 0
    v_mfma_f32_16x16x32_bf16 v[52:55], v[148:151], v[80:83], v[52:55]
    ds_read_b128 v[112:115], v36 offset:128
    ds_read_b128 v[116:119], v36 offset:640
    v_mfma_f32_16x16x32_bf16 v[56:59], v[148:151], v[84:87], v[56:59]
    ds_read_b128 v[120:123], v36 offset:1152
    v_mfma_f32_16x16x32_bf16 v[60:63], v[148:151], v[88:91], v[60:63]
    ds_read_b128 v[124:127], v36 offset:1664
    v_mfma_f32_16x16x32_bf16 v[64:67], v[148:151], v[92:95], v[64:67]
    ds_read_b128 v[128:131], v36 offset:2176
    v_mfma_f32_16x16x32_bf16 v[68:71], v[148:151], v[96:99], v[68:71]
    ds_read_b128 v[132:135], v36 offset:2688
    v_mfma_f32_16x16x32_bf16 v[72:75], v[148:151], v[100:103], v[72:75]
    ds_read_b128 v[136:139], v36 offset:3200
    v_mfma_f32_16x16x32_bf16 v[76:79], v[148:151], v[104:107], v[76:79]
    ds_read_b128 v[140:143], v36 offset:3712
    v_mfma_f32_16x16x32_bf16 v[56:59], v[152:155], v[80:83], v[56:59]
    ds_read2_b32 v[208:209], v32 offset0:160 offset1:161
    v_mfma_f32_16x16x32_bf16 v[60:63], v[152:155], v[84:87], v[60:63]
    ds_read2_b32 v[210:211], v32 offset0:162 offset1:163
    v_mfma_f32_16x16x32_bf16 v[64:67], v[152:155], v[88:91], v[64:67]
    ds_read2_b32 v[212:213], v32 offset0:32 offset1:33
    v_mfma_f32_16x16x32_bf16 v[68:71], v[152:155], v[92:95], v[68:71]
    ds_read2_b32 v[214:215], v32 offset0:34 offset1:35
    v_mfma_f32_16x16x32_bf16 v[72:75], v[152:155], v[96:99], v[72:75]
    ds_read2_b32 v[216:217], v33 offset0:160 offset1:161
    ds_read2_b32 v[218:219], v33 offset0:162 offset1:163
    v_mfma_f32_16x16x32_bf16 v[76:79], v[152:155], v[100:103], v[76:79]
    ds_read2_b32 v[220:221], v33 offset0:32 offset1:33
    v_mfma_f32_16x16x32_bf16 v[60:63], v[156:159], v[80:83], v[60:63]
    ds_read2_b32 v[222:223], v33 offset0:34 offset1:35
    v_mfma_f32_16x16x32_bf16 v[64:67], v[156:159], v[84:87], v[64:67]
    ds_read2_b32 v[224:225], v34 offset0:160 offset1:161
    v_mfma_f32_16x16x32_bf16 v[68:71], v[156:159], v[88:91], v[68:71]
    ds_read2_b32 v[226:227], v34 offset0:162 offset1:163
    v_mfma_f32_16x16x32_bf16 v[72:75], v[156:159], v[92:95], v[72:75]
    ds_read2_b32 v[228:229], v34 offset0:32 offset1:33
    v_mfma_f32_16x16x32_bf16 v[76:79], v[156:159], v[96:99], v[76:79]
    ds_read2_b32 v[230:231], v34 offset0:34 offset1:35
    v_mfma_f32_16x16x32_bf16 v[64:67], v[160:163], v[80:83], v[64:67]
    ds_read2_b32 v[232:233], v35 offset0:160 offset1:161
    v_mfma_f32_16x16x32_bf16 v[68:71], v[160:163], v[84:87], v[68:71]
    ds_read2_b32 v[234:235], v35 offset0:162 offset1:163
    v_mfma_f32_16x16x32_bf16 v[72:75], v[160:163], v[88:91], v[72:75]
    ds_read2_b32 v[236:237], v35 offset0:32 offset1:33
    v_mfma_f32_16x16x32_bf16 v[76:79], v[160:163], v[92:95], v[76:79]
    ds_read2_b32 v[238:239], v35 offset0:34 offset1:35
    v_mfma_f32_16x16x32_bf16 v[68:71], v[164:167], v[80:83], v[68:71]
    v_mfma_f32_16x16x32_bf16 v[72:75], v[164:167], v[84:87], v[72:75]
    v_mfma_f32_16x16x32_bf16 v[76:79], v[164:167], v[88:91], v[76:79]
    v_mfma_f32_16x16x32_bf16 v[72:75], v[168:171], v[80:83], v[72:75]
    v_mfma_f32_16x16x32_bf16 v[76:79], v[168:171], v[84:87], v[76:79]
    v_mfma_f32_16x16x32_bf16 v[76:79], v[172:175], v[80:83], v[76:79]
    s_waitcnt lgkmcnt(0)
    v_mfma_f32_16x16x32_bf16 v[48:51], v[208:211], v[112:115], v[48:51]
    ds_read_b128 v[80:83], v36 offset:64
    v_mfma_f32_16x16x32_bf16 v[52:55], v[208:211], v[116:119], v[52:55]
    ds_read_b128 v[84:87], v36 offset:576
    v_mfma_f32_16x16x32_bf16 v[56:59], v[208:211], v[120:123], v[56:59]
    ds_read_b128 v[88:91], v36 offset:1088
    v_mfma_f32_16x16x32_bf16 v[60:63], v[208:211], v[124:127], v[60:63]
    ds_read_b128 v[92:95], v36 offset:1600
    v_mfma_f32_16x16x32_bf16 v[64:67], v[208:211], v[128:131], v[64:67]
    ds_read_b128 v[96:99], v36 offset:2112
    v_mfma_f32_16x16x32_bf16 v[68:71], v[208:211], v[132:135], v[68:71]
    ds_read_b128 v[100:103], v36 offset:2624
    v_mfma_f32_16x16x32_bf16 v[72:75], v[208:211], v[136:139], v[72:75]
    ds_read_b128 v[104:107], v36 offset:3136
    v_mfma_f32_16x16x32_bf16 v[76:79], v[208:211], v[140:143], v[76:79]
    ds_read_b128 v[108:111], v36 offset:3648
    v_mfma_f32_16x16x32_bf16 v[52:55], v[212:215], v[112:115], v[52:55]
    ds_read2_b32 v[144:145], v32 offset0:144 offset1:145
    v_mfma_f32_16x16x32_bf16 v[56:59], v[212:215], v[116:119], v[56:59]
    ds_read2_b32 v[146:147], v32 offset0:146 offset1:147
    v_mfma_f32_16x16x32_bf16 v[60:63], v[212:215], v[120:123], v[60:63]
    ds_read2_b32 v[148:149], v32 offset0:16 offset1:17
    v_mfma_f32_16x16x32_bf16 v[64:67], v[212:215], v[124:127], v[64:67]
    ds_read2_b32 v[150:151], v32 offset0:18 offset1:19
    v_mfma_f32_16x16x32_bf16 v[68:71], v[212:215], v[128:131], v[68:71]
    v_mfma_f32_16x16x32_bf16 v[72:75], v[212:215], v[132:135], v[72:75]
    ds_read2_b32 v[152:153], v33 offset0:144 offset1:145
    v_mfma_f32_16x16x32_bf16 v[76:79], v[212:215], v[136:139], v[76:79]
    ds_read2_b32 v[154:155], v33 offset0:146 offset1:147
    v_mfma_f32_16x16x32_bf16 v[56:59], v[216:219], v[112:115], v[56:59]
    ds_read2_b32 v[156:157], v33 offset0:16 offset1:17
    v_mfma_f32_16x16x32_bf16 v[60:63], v[216:219], v[116:119], v[60:63]
    ds_read2_b32 v[158:159], v33 offset0:18 offset1:19
    v_mfma_f32_16x16x32_bf16 v[64:67], v[216:219], v[120:123], v[64:67]
    ds_read2_b32 v[160:161], v34 offset0:144 offset1:145
    v_mfma_f32_16x16x32_bf16 v[68:71], v[216:219], v[124:127], v[68:71]
    ds_read2_b32 v[162:163], v34 offset0:146 offset1:147
    v_mfma_f32_16x16x32_bf16 v[72:75], v[216:219], v[128:131], v[72:75]
    ds_read2_b32 v[164:165], v34 offset0:16 offset1:17
    v_mfma_f32_16x16x32_bf16 v[76:79], v[216:219], v[132:135], v[76:79]
    ds_read2_b32 v[166:167], v34 offset0:18 offset1:19
    v_mfma_f32_16x16x32_bf16 v[60:63], v[220:223], v[112:115], v[60:63]
    ds_read2_b32 v[168:169], v35 offset0:144 offset1:145
    v_mfma_f32_16x16x32_bf16 v[64:67], v[220:223], v[116:119], v[64:67]
    ds_read2_b32 v[170:171], v35 offset0:146 offset1:147
    v_mfma_f32_16x16x32_bf16 v[68:71], v[220:223], v[120:123], v[68:71]
    ds_read2_b32 v[172:173], v35 offset0:16 offset1:17
    v_mfma_f32_16x16x32_bf16 v[72:75], v[220:223], v[124:127], v[72:75]
    ds_read2_b32 v[174:175], v35 offset0:18 offset1:19
    v_mfma_f32_16x16x32_bf16 v[76:79], v[220:223], v[128:131], v[76:79]
    v_mfma_f32_16x16x32_bf16 v[64:67], v[224:227], v[112:115], v[64:67]
    v_mfma_f32_16x16x32_bf16 v[68:71], v[224:227], v[116:119], v[68:71]
    v_mfma_f32_16x16x32_bf16 v[72:75], v[224:227], v[120:123], v[72:75]
    v_mfma_f32_16x16x32_bf16 v[76:79], v[224:227], v[124:127], v[76:79]
    v_mfma_f32_16x16x32_bf16 v[68:71], v[228:231], v[112:115], v[68:71]
    v_mfma_f32_16x16x32_bf16 v[72:75], v[228:231], v[116:119], v[72:75]
    v_mfma_f32_16x16x32_bf16 v[76:79], v[228:231], v[120:123], v[76:79]
    v_mfma_f32_16x16x32_bf16 v[72:75], v[232:235], v[112:115], v[72:75]
    v_mfma_f32_16x16x32_bf16 v[76:79], v[232:235], v[116:119], v[76:79]
    v_mfma_f32_16x16x32_bf16 v[76:79], v[236:239], v[112:115], v[76:79]
    s_waitcnt lgkmcnt(0)
    v_mfma_f32_16x16x32_bf16 v[48:51], v[144:147], v[80:83], v[48:51]
    ds_read_b128 v[112:115], v36 offset:0
    v_mfma_f32_16x16x32_bf16 v[52:55], v[144:147], v[84:87], v[52:55]
    ds_read_b128 v[116:119], v36 offset:512
    v_mfma_f32_16x16x32_bf16 v[56:59], v[144:147], v[88:91], v[56:59]
    ds_read_b128 v[120:123], v36 offset:1024
    v_mfma_f32_16x16x32_bf16 v[60:63], v[144:147], v[92:95], v[60:63]
    ds_read_b128 v[124:127], v36 offset:1536
    v_mfma_f32_16x16x32_bf16 v[64:67], v[144:147], v[96:99], v[64:67]
    ds_read_b128 v[128:131], v36 offset:2048
    v_mfma_f32_16x16x32_bf16 v[68:71], v[144:147], v[100:103], v[68:71]
    ds_read_b128 v[132:135], v36 offset:2560
    v_mfma_f32_16x16x32_bf16 v[72:75], v[144:147], v[104:107], v[72:75]
    ds_read_b128 v[136:139], v36 offset:3072
    v_mfma_f32_16x16x32_bf16 v[76:79], v[144:147], v[108:111], v[76:79]
    ds_read_b128 v[140:143], v36 offset:3584
    v_mfma_f32_16x16x32_bf16 v[52:55], v[148:151], v[80:83], v[52:55]
    ds_read2_b32 v[208:209], v32 offset0:128 offset1:129
    v_mfma_f32_16x16x32_bf16 v[56:59], v[148:151], v[84:87], v[56:59]
    ds_read2_b32 v[210:211], v32 offset0:130 offset1:131
    v_mfma_f32_16x16x32_bf16 v[60:63], v[148:151], v[88:91], v[60:63]
    ds_read2_b32 v[212:213], v32 offset0:0 offset1:1
    v_mfma_f32_16x16x32_bf16 v[64:67], v[148:151], v[92:95], v[64:67]
    ds_read2_b32 v[214:215], v32 offset0:2 offset1:3
    v_mfma_f32_16x16x32_bf16 v[68:71], v[148:151], v[96:99], v[68:71]
    v_mfma_f32_16x16x32_bf16 v[72:75], v[148:151], v[100:103], v[72:75]
    ds_read2_b32 v[216:217], v33 offset0:128 offset1:129
    v_mfma_f32_16x16x32_bf16 v[76:79], v[148:151], v[104:107], v[76:79]
    ds_read2_b32 v[218:219], v33 offset0:130 offset1:131
    v_mfma_f32_16x16x32_bf16 v[56:59], v[152:155], v[80:83], v[56:59]
    ds_read2_b32 v[220:221], v33 offset0:0 offset1:1
    v_mfma_f32_16x16x32_bf16 v[60:63], v[152:155], v[84:87], v[60:63]
    ds_read2_b32 v[222:223], v33 offset0:2 offset1:3
    v_mfma_f32_16x16x32_bf16 v[64:67], v[152:155], v[88:91], v[64:67]
    ds_read2_b32 v[224:225], v34 offset0:128 offset1:129
    v_mfma_f32_16x16x32_bf16 v[68:71], v[152:155], v[92:95], v[68:71]
    ds_read2_b32 v[226:227], v34 offset0:130 offset1:131
    v_mfma_f32_16x16x32_bf16 v[72:75], v[152:155], v[96:99], v[72:75]
    ds_read2_b32 v[228:229], v34 offset0:0 offset1:1
    v_mfma_f32_16x16x32_bf16 v[76:79], v[152:155], v[100:103], v[76:79]
    ds_read2_b32 v[230:231], v34 offset0:2 offset1:3
    v_mfma_f32_16x16x32_bf16 v[60:63], v[156:159], v[80:83], v[60:63]
    ds_read2_b32 v[232:233], v35 offset0:128 offset1:129
    v_mfma_f32_16x16x32_bf16 v[64:67], v[156:159], v[84:87], v[64:67]
    ds_read2_b32 v[234:235], v35 offset0:130 offset1:131
    v_mfma_f32_16x16x32_bf16 v[68:71], v[156:159], v[88:91], v[68:71]
    ds_read2_b32 v[236:237], v35 offset0:0 offset1:1
    v_mfma_f32_16x16x32_bf16 v[72:75], v[156:159], v[92:95], v[72:75]
    ds_read2_b32 v[238:239], v35 offset0:2 offset1:3
    v_mfma_f32_16x16x32_bf16 v[76:79], v[156:159], v[96:99], v[76:79]
    v_mfma_f32_16x16x32_bf16 v[64:67], v[160:163], v[80:83], v[64:67]
    v_mfma_f32_16x16x32_bf16 v[68:71], v[160:163], v[84:87], v[68:71]
    v_mfma_f32_16x16x32_bf16 v[72:75], v[160:163], v[88:91], v[72:75]
    v_mfma_f32_16x16x32_bf16 v[76:79], v[160:163], v[92:95], v[76:79]
    v_mfma_f32_16x16x32_bf16 v[68:71], v[164:167], v[80:83], v[68:71]
    v_mfma_f32_16x16x32_bf16 v[72:75], v[164:167], v[84:87], v[72:75]
    v_mfma_f32_16x16x32_bf16 v[76:79], v[164:167], v[88:91], v[76:79]
    v_mfma_f32_16x16x32_bf16 v[72:75], v[168:171], v[80:83], v[72:75]
    v_mfma_f32_16x16x32_bf16 v[76:79], v[168:171], v[84:87], v[76:79]
    v_mfma_f32_16x16x32_bf16 v[76:79], v[172:175], v[80:83], v[76:79]
    s_waitcnt lgkmcnt(0)
    v_mfma_f32_16x16x32_bf16 v[48:51], v[208:211], v[112:115], v[48:51]
    ds_read_b64 v[196:197], v37 offset:512
    v_mfma_f32_16x16x32_bf16 v[52:55], v[208:211], v[116:119], v[52:55]
    v_mfma_f32_16x16x32_bf16 v[56:59], v[208:211], v[120:123], v[56:59]
    ds_read_b64 v[198:199], v37 offset:1024
    v_mfma_f32_16x16x32_bf16 v[60:63], v[208:211], v[124:127], v[60:63]
    v_mfma_f32_16x16x32_bf16 v[64:67], v[208:211], v[128:131], v[64:67]
    ds_read_b64 v[200:201], v37 offset:1536
    v_mfma_f32_16x16x32_bf16 v[68:71], v[208:211], v[132:135], v[68:71]
    v_mfma_f32_16x16x32_bf16 v[72:75], v[208:211], v[136:139], v[72:75]
    ds_read_b64 v[202:203], v37 offset:2048
    v_mfma_f32_16x16x32_bf16 v[76:79], v[208:211], v[140:143], v[76:79]
    v_mfma_f32_16x16x32_bf16 v[52:55], v[212:215], v[112:115], v[52:55]
    v_mfma_f32_16x16x32_bf16 v[56:59], v[212:215], v[116:119], v[56:59]
    v_mfma_f32_16x16x32_bf16 v[60:63], v[212:215], v[120:123], v[60:63]
    v_mfma_f32_16x16x32_bf16 v[64:67], v[212:215], v[124:127], v[64:67]
    v_mfma_f32_16x16x32_bf16 v[68:71], v[212:215], v[128:131], v[68:71]
    v_mfma_f32_16x16x32_bf16 v[72:75], v[212:215], v[132:135], v[72:75]
    v_mfma_f32_16x16x32_bf16 v[76:79], v[212:215], v[136:139], v[76:79]
    v_mfma_f32_16x16x32_bf16 v[56:59], v[216:219], v[112:115], v[56:59]
    v_mfma_f32_16x16x32_bf16 v[60:63], v[216:219], v[116:119], v[60:63]
    v_mfma_f32_16x16x32_bf16 v[64:67], v[216:219], v[120:123], v[64:67]
    v_mfma_f32_16x16x32_bf16 v[68:71], v[216:219], v[124:127], v[68:71]
    v_mfma_f32_16x16x32_bf16 v[72:75], v[216:219], v[128:131], v[72:75]
    v_mfma_f32_16x16x32_bf16 v[76:79], v[216:219], v[132:135], v[76:79]
    v_mfma_f32_16x16x32_bf16 v[60:63], v[220:223], v[112:115], v[60:63]
    v_mfma_f32_16x16x32_bf16 v[64:67], v[220:223], v[116:119], v[64:67]
    v_mfma_f32_16x16x32_bf16 v[68:71], v[220:223], v[120:123], v[68:71]
    v_mfma_f32_16x16x32_bf16 v[72:75], v[220:223], v[124:127], v[72:75]
    v_mfma_f32_16x16x32_bf16 v[76:79], v[220:223], v[128:131], v[76:79]
    v_mfma_f32_16x16x32_bf16 v[64:67], v[224:227], v[112:115], v[64:67]
    v_mfma_f32_16x16x32_bf16 v[68:71], v[224:227], v[116:119], v[68:71]
    v_mfma_f32_16x16x32_bf16 v[72:75], v[224:227], v[120:123], v[72:75]
    v_mfma_f32_16x16x32_bf16 v[76:79], v[224:227], v[124:127], v[76:79]
    v_mfma_f32_16x16x32_bf16 v[68:71], v[228:231], v[112:115], v[68:71]
    v_mfma_f32_16x16x32_bf16 v[72:75], v[228:231], v[116:119], v[72:75]
    v_mfma_f32_16x16x32_bf16 v[76:79], v[228:231], v[120:123], v[76:79]
    v_mfma_f32_16x16x32_bf16 v[72:75], v[232:235], v[112:115], v[72:75]
    v_mfma_f32_16x16x32_bf16 v[76:79], v[232:235], v[116:119], v[76:79]
    v_mfma_f32_16x16x32_bf16 v[76:79], v[236:239], v[112:115], v[76:79]
    s_cmp_eq_u32 s36, 1
    s_cbranch_scc1 L_cv_x1
    ds_write_b128 v39, v[64:67] offset:4096
    ds_write_b128 v39, v[68:71] offset:5120
    s_nop 1
    ds_write_b128 v39, v[72:75] offset:6144
    s_nop 0
    ds_write_b128 v39, v[76:79] offset:7168
    ds_write_b32 v14, v13
    s_branch L_cv_out
L_cv_x1:
    s_nop 7
    ds_write_b128 v39, v[48:51] offset:4096
    ds_write_b128 v39, v[52:55] offset:5120
    ds_write_b128 v39, v[56:59] offset:6144
    ds_write_b128 v39, v[60:63] offset:7168
    ds_write_b32 v14, v13
    v_mov_b32 v48, v64
    v_mov_b32 v49, v65
    v_mov_b32 v50, v66
    v_mov_b32 v51, v67
    v_mov_b32 v52, v68
    v_mov_b32 v53, v69
    v_mov_b32 v54, v70
    v_mov_b32 v55, v71
    v_mov_b32 v56, v72
    v_mov_b32 v57, v73
    v_mov_b32 v58, v74
    v_mov_b32 v59, v75
    v_mov_b32 v60, v76
    v_mov_b32 v61, v77
    v_mov_b32 v62, v78
    v_mov_b32 v63, v79
L_cv_out:
    v_lshrrev_b32 v41, 3, v0
    v_and_b32 v42, 7, v0
    v_lshlrev_b32 v41, 13, v41
    v_lshl_add_u32 v41, v42, 4, v41
    s_lshr_b32 s28, s39, 1
    s_lshl_b32 s31, s2, 1
    s_add_u32 s31, s31, s28
    s_lshr_b32 s29, s31, 6
    s_lshl_b32 s29, s29, 18
    s_and_b32 s28, s31, 63
    s_lshl_b32 s28, s28, 7
    s_add_u32 s29, s29, s28
    s_add_u32 s29, s29, 12582912
    s_and_b32 s30, s39, 1
    s_lshl_b32 s30, s30, 17
    s_add_u32 s30, s30, s29
    s_add_u32 s31, s30, 65536
    v_mov_b32 v44, 0xfffffffe
    s_waitcnt lgkmcnt(5)
    v_lshlrev_b32 v80, 16, v196
    v_and_b32 v81, 0xffff0000, v196
    v_lshlrev_b32 v82, 16, v197
    v_and_b32 v83, 0xffff0000, v197
    v_lshlrev_b32 v84, 16, v198
    v_and_b32 v85, 0xffff0000, v198
    v_lshlrev_b32 v86, 16, v199
    v_and_b32 v87, 0xffff0000, v199
    v_lshlrev_b32 v88, 16, v200
    v_and_b32 v89, 0xffff0000, v200
    v_lshlrev_b32 v90, 16, v201
    v_and_b32 v91, 0xffff0000, v201
    v_lshlrev_b32 v92, 16, v202
    v_and_b32 v93, 0xffff0000, v202
    v_lshlrev_b32 v94, 16, v203
    v_and_b32 v95, 0xffff0000, v203
    v_fma_f32 v48, v80, v251, v48
    v_fma_f32 v49, v81, v251, v49
    v_fma_f32 v50, v82, v251, v50
    v_fma_f32 v51, v83, v251, v51
    v_fma_f32 v52, v84, v251, v52
    v_fma_f32 v53, v85, v251, v53
    v_fma_f32 v54, v86, v251, v54
    v_fma_f32 v55, v87, v251, v55
    v_fma_f32 v56, v88, v251, v56
    v_fma_f32 v57, v89, v251, v57
    v_fma_f32 v58, v90, v251, v58
    v_fma_f32 v59, v91, v251, v59
    v_fma_f32 v60, v92, v251, v60
    v_fma_f32 v61, v93, v251, v61
    v_fma_f32 v62, v94, v251, v62
    v_fma_f32 v63, v95, v251, v63
L_cv_ps1:
    ds_read_b32 v16, v15
    s_waitcnt lgkmcnt(0)
    v_readfirstlane_b32 s28, v16
    s_nop 0
    s_cmp_eq_u32 s28, 1
    s_cbranch_scc0 L_cv_ps1
    ds_read_b128 v[112:115], v40 offset:4096
    ds_read_b128 v[116:119], v40 offset:5120
    ds_read_b128 v[120:123], v40 offset:6144
    ds_read_b128 v[124:127], v40 offset:7168
    s_waitcnt lgkmcnt(3)
    v_add_f32 v48, v48, v112
    v_add_f32 v49, v49, v113
    v_add_f32 v50, v50, v114
    v_add_f32 v51, v51, v115
    v_cvt_pk_bf16_f32 v96, v48, v49
    v_cvt_pk_bf16_f32 v97, v50, v51
    v_min_u32 v96, v96, v44
    v_min_u32 v97, v97, v44
    ds_write_b64 v38, v[96:97] offset:0
    s_waitcnt lgkmcnt(3)
    v_add_f32 v52, v52, v116
    v_add_f32 v53, v53, v117
    v_add_f32 v54, v54, v118
    v_add_f32 v55, v55, v119
    v_cvt_pk_bf16_f32 v98, v52, v53
    v_cvt_pk_bf16_f32 v99, v54, v55
    v_min_u32 v98, v98, v44
    v_min_u32 v99, v99, v44
    ds_write_b64 v38, v[98:99] offset:512
    s_waitcnt lgkmcnt(3)
    v_add_f32 v56, v56, v120
    v_add_f32 v57, v57, v121
    v_add_f32 v58, v58, v122
    v_add_f32 v59, v59, v123
    v_cvt_pk_bf16_f32 v100, v56, v57
    v_cvt_pk_bf16_f32 v101, v58, v59
    v_min_u32 v100, v100, v44
    v_min_u32 v101, v101, v44
    ds_write_b64 v38, v[100:101] offset:1024
    s_waitcnt lgkmcnt(3)
    v_add_f32 v60, v60, v124
    v_add_f32 v61, v61, v125
    v_add_f32 v62, v62, v126
    v_add_f32 v63, v63, v127
    v_cvt_pk_bf16_f32 v102, v60, v61
    v_cvt_pk_bf16_f32 v103, v62, v63
    v_min_u32 v102, v102, v44
    v_min_u32 v103, v103, v44
    ds_write_b64 v38, v[102:103] offset:1536
    ds_read_b128 v[80:83], v39 offset:0
    ds_read_b128 v[84:87], v39 offset:1024
    s_waitcnt lgkmcnt(1)
    buffer_store_dwordx4 v[80:83], v41, s[12:15], s30 offen sc1
    s_waitcnt lgkmcnt(0)
    buffer_store_dwordx4 v[84:87], v41, s[12:15], s31 offen sc1
    v_lshlrev_b32 v42, 8, v1
    v_lshl_add_u32 v42, v2, 4, v42
    s_lshl_b32 s28, s79, 5
    s_add_u32 s28, s28, s78
    s_lshl_b32 s28, s28, 13
    s_lshl_b32 s29, s21, 11
    s_add_u32 s28, s28, s29
    s_add_u32 s28, s28, 12582912
    v_lshlrev_b32 v43, 8, v2
    v_lshl_add_u32 v43, v2, 4, v43
    v_lshl_add_u32 v43, v1, 2, v43
    v_add_u32 v43, s27, v43
    v_mov_b32 v45, 0x05040100
    v_mov_b32 v46, 0x07060302
    s_mov_b32 s30, 0
    v_mov_b32 v17, 157232
    s_setprio 1
L_cv_w19:
    s_sleep 2
    ds_read_b128 v[20:23], v17
    s_waitcnt lgkmcnt(0)
    v_and_b32 v20, v20, v21
    v_and_b32 v22, v22, v23
    v_and_b32 v20, v20, v22
    s_nop 0
    v_readfirstlane_b32 s29, v20
    s_nop 0
    s_cmp_eq_u32 s29, 1
    s_cbranch_scc0 L_cv_w19
L_cv_poll2:
    buffer_load_dwordx4 v[160:163], v42, s[12:15], s28 offen sc1
    buffer_load_dwordx4 v[164:167], v42, s[12:15], s28 offen offset:128 sc1
    s_waitcnt vmcnt(0)
    v_max_u32 v168, v160, v161
    v_max3_u32 v168, v168, v162, v163
    v_max3_u32 v168, v168, v164, v165
    v_max3_u32 v168, v168, v166, v167
    v_cmp_eq_u32 vcc, -1, v168
    s_nop 0
    s_cbranch_vccz L_cv_got
    s_sleep 4
    s_add_u32 s30, s30, 1
    s_cmp_lt_u32 s30, 262144
    s_cbranch_scc1 L_cv_poll2
L_cv_got:
    v_perm_b32 v168, v164, v160, v45
    v_perm_b32 v169, v164, v160, v46
    v_perm_b32 v170, v165, v161, v45
    v_perm_b32 v171, v165, v161, v46
    v_perm_b32 v172, v166, v162, v45
    v_perm_b32 v173, v166, v162, v46
    v_perm_b32 v174, v167, v163, v45
    v_perm_b32 v175, v167, v163, v46
    ds_write_b32 v43, v168 offset:0
    ds_write_b32 v43, v169 offset:32
    ds_write_b32 v43, v170 offset:64
    ds_write_b32 v43, v171 offset:96
    ds_write_b32 v43, v172 offset:128
    ds_write_b32 v43, v173 offset:160
    ds_write_b32 v43, v174 offset:192
    ds_write_b32 v43, v175 offset:224
    s_waitcnt lgkmcnt(0)
L_final:
    s_nop 7
    v_lshlrev_b32 v13, 1, v2
    v_xor_b32 v13, v13, v1
    v_lshlrev_b32 v13, 4, v13
    v_lshl_add_u32 v13, v1, 8, v13
    s_and_b32 s28, s20, 3
    s_lshl_b32 s28, s28, 11
    s_lshr_b32 s29, s20, 2
    s_lshl_b32 s29, s29, 15
    s_add_u32 s28, s28, s29
    v_add_u32 v13, s28, v13
    v_xor_b32 v14, 16, v13
    v_lshrrev_b32 v15, 1, v2
    v_lshlrev_b32 v15, 13, v15
    v_lshl_add_u32 v15, v1, 5, v15
    v_and_b32 v16, 1, v2
    v_lshl_add_u32 v15, v16, 4, v15
    s_mul_i32 s28, s20, 272
    s_add_u32 s28, s28, 98304
    v_add_u32 v15, s28, v15
    s_mov_b32 s8, s52
    s_mov_b32 s9, s53
    s_mov_b32 s10, 2097152
    s_mov_b32 s11, 0x00020000
    v_lshlrev_b32 v64, 16, v4
    v_and_b32 v65, 0xffff0000, v4
    v_lshlrev_b32 v66, 16, v5
    v_and_b32 v67, 0xffff0000, v5
    v_lshlrev_b32 v68, 16, v6
    v_and_b32 v69, 0xffff0000, v6
    v_lshlrev_b32 v70, 16, v7
    v_and_b32 v71, 0xffff0000, v7
    v_lshlrev_b32 v80, 16, v8
    v_and_b32 v81, 0xffff0000, v8
    v_lshlrev_b32 v82, 16, v9
    v_and_b32 v83, 0xffff0000, v9
    v_lshlrev_b32 v84, 16, v10
    v_and_b32 v85, 0xffff0000, v10
    v_lshlrev_b32 v86, 16, v11
    v_and_b32 v87, 0xffff0000, v11
    v_add_f32 v64, v64, v80
    v_add_f32 v65, v65, v81
    v_add_f32 v66, v66, v82
    v_add_f32 v67, v67, v83
    v_add_f32 v68, v68, v84
    v_add_f32 v69, v69, v85
    v_add_f32 v70, v70, v86
    v_add_f32 v71, v71, v87
    s_barrier
    ds_read_b128 v[16:19], v15
    ds_read_b128 v[32:35], v13 offset:0
    ds_read_b128 v[36:39], v14 offset:0
    ds_read_b128 v[40:43], v13 offset:8192
    ds_read_b128 v[44:47], v14 offset:8192
    ds_read_b128 v[48:51], v13 offset:16384
    ds_read_b128 v[52:55], v14 offset:16384
    ds_read_b128 v[56:59], v13 offset:24576
    ds_read_b128 v[60:63], v14 offset:24576
    s_waitcnt lgkmcnt(8)
    v_lshlrev_b32 v72, 16, v16
    v_and_b32 v73, 0xffff0000, v16
    v_lshlrev_b32 v74, 16, v17
    v_and_b32 v75, 0xffff0000, v17
    v_lshlrev_b32 v76, 16, v18
    v_and_b32 v77, 0xffff0000, v18
    v_lshlrev_b32 v78, 16, v19
    v_and_b32 v79, 0xffff0000, v19
    v_add_f32 v64, v64, v72
    v_add_f32 v65, v65, v73
    v_add_f32 v66, v66, v74
    v_add_f32 v67, v67, v75
    v_add_f32 v68, v68, v76
    v_add_f32 v69, v69, v77
    v_add_f32 v70, v70, v78
    v_add_f32 v71, v71, v79
    s_waitcnt lgkmcnt(4)
    v_add_f32 v32, v32, v40
    v_add_f32 v33, v33, v41
    v_add_f32 v34, v34, v42
    v_add_f32 v35, v35, v43
    v_add_f32 v36, v36, v44
    v_add_f32 v37, v37, v45
    v_add_f32 v38, v38, v46
    v_add_f32 v39, v39, v47
    s_waitcnt lgkmcnt(0)
    v_add_f32 v48, v48, v56
    v_add_f32 v49, v49, v57
    v_add_f32 v50, v50, v58
    v_add_f32 v51, v51, v59
    v_add_f32 v52, v52, v60
    v_add_f32 v53, v53, v61
    v_add_f32 v54, v54, v62
    v_add_f32 v55, v55, v63
    v_add_f32 v32, v32, v48
    v_add_f32 v33, v33, v49
    v_add_f32 v34, v34, v50
    v_add_f32 v35, v35, v51
    v_add_f32 v36, v36, v52
    v_add_f32 v37, v37, v53
    v_add_f32 v38, v38, v54
    v_add_f32 v39, v39, v55
    v_add_f32 v32, v32, v64
    v_add_f32 v33, v33, v65
    v_add_f32 v34, v34, v66
    v_add_f32 v35, v35, v67
    v_add_f32 v36, v36, v68
    v_add_f32 v37, v37, v69
    v_add_f32 v38, v38, v70
    v_add_f32 v39, v39, v71
    v_cvt_pk_bf16_f32 v28, v32, v33
    v_cvt_pk_bf16_f32 v29, v34, v35
    v_cvt_pk_bf16_f32 v30, v36, v37
    v_cvt_pk_bf16_f32 v31, v38, v39
    buffer_store_dwordx4 v[28:31], v12, s[8:11], s33 offen
    s_endpgm
L_exit:
    s_endpgm
.section .rodata,"a"
.p2align 6
.amdhsa_kernel parallel_sum__ssm_conv_s4__dense_activation_gelu__prompt_kernel
  .amdhsa_next_free_vgpr 256
  .amdhsa_next_free_sgpr 102
  .amdhsa_accum_offset 256
  .amdhsa_group_segment_fixed_size 0
  .amdhsa_kernarg_size 136
  .amdhsa_user_sgpr_count 2
  .amdhsa_user_sgpr_kernarg_segment_ptr 1
  .amdhsa_system_sgpr_workgroup_id_x 1
.end_amdhsa_kernel
```
